```python
import torch

def _softmax(x, axis=-1):
    return torch.softmax(x, dim=axis)
def _gelu(x):
    return torch.nn.functional.gelu(x, approximate="tanh")
def _silu(x):
    return torch.nn.functional.silu(x)
def _sigmoid(x):
    return torch.sigmoid(x)
def _layernorm(x, axis=-1, eps=1e-5):
    m = x.mean(dim=axis, keepdim=True)
    v = x.var(dim=axis, keepdim=True, unbiased=False)
    return (x - m) / torch.sqrt(v + eps)
def _scatter_add(tgt, idx, src, axis=0):
    return tgt.clone().index_add_(axis, idx, src)
def _segment_sum(src, seg, n):
    out = torch.zeros((n,) + src.shape[1:], dtype=src.dtype)
    return out.index_add_(0, seg, src)
def _pad(x, pw):
    flat = tuple(v for pair in reversed(pw) for v in pair)
    return torch.nn.functional.pad(x, flat)

kernel_name = 'standalone__gqa_block_cached__sampling'

def setup_inputs():

    _w = (lambda a: (lambda t: t.to(torch.bfloat16) if t.is_floating_point() else t)(torch.as_tensor(a)))
    B, Sq, D = 8, 4, 512
    Hq, Hkv, Sk, Dh = 32, 8, 4096, 128
    assert Hq % Hkv == 0, (Hq, Hkv)
    return {
        "x": _w((lambda *s: torch.randn(*s, dtype=torch.bfloat16) * 0.8)(B, Sq, D)),
        "k_cache": _w((lambda *s: torch.randn(*s, dtype=torch.bfloat16) * 0.8)(B, Hkv, Sk, Dh)),
        "v_cache": _w((lambda *s: torch.randn(*s, dtype=torch.bfloat16) * 0.05)(B, Hkv, Sk, Dh)),
        "wq": _w((lambda *s: torch.randn(*s, dtype=torch.bfloat16) * 0.8)(D, Hq * Dh) * (D ** -0.5)),
        "wo": _w((lambda *s: torch.randn(*s, dtype=torch.bfloat16) * 0.05)(Hq * Dh, D) * ((Hq * Dh) ** -0.5)),
    }

def reference(x, k_cache, v_cache, wq, wo):
    B, Sq, D = x.shape
    Hq, Dh = 32, 128
    Hkv = k_cache.shape[1]
    rep = Hq // Hkv
    q = (lambda x, *d: x.permute(*d))((x @ wq).reshape(B, Sq, Hq, Dh), 0, 2, 1, 3)
    k = (lambda x, n, axis: torch.repeat_interleave(x, n, dim=axis))(k_cache, rep, axis=1)
    v = (lambda x, n, axis: torch.repeat_interleave(x, n, dim=axis))(v_cache, rep, axis=1)
    scores = torch.einsum("bhqd,bhkd->bhqk", q, k) * (Dh ** -0.5)
    p = _softmax(scores, axis=-1)
    o = torch.einsum("bhqk,bhkd->bhqd", p, v)
    return (lambda x, *d: x.permute(*d))(o, 0, 2, 1, 3).reshape(B, Sq, Hq * Dh) @ wo
```

```asm
; @launch kernel=qproj_kernel grid=(128,1,1) block=(256,1,1) lds=16384
; @launch kernel=attn_kernel grid=(256,1,1) block=(256,1,1) lds=33280
; @launch kernel=oproj_kernel grid=(128,1,1) block=(64,1,1) lds=0
; @launch kernel=oreduce_kernel grid=(64,1,1) block=(64,1,1) lds=0
.amdgcn_target "amdgcn-amd-amdhsa--gfx950"
.text
.globl qproj_kernel
.p2align 8
.type qproj_kernel,@function
qproj_kernel:
    s_cmp_ge_u32 s2, 128
    s_cbranch_scc1 qproj_kernel_end
    s_load_dwordx2 s[4:5], s[0:1], 0
    s_load_dwordx2 s[6:7], s[0:1], 24
    s_load_dwordx2 s[8:9], s[0:1], 56
    v_lshrrev_b32 v4, 6, v0
    v_and_b32 v1, 63, v0
    v_readfirstlane_b32 s24, v4
    v_and_b32 v2, 15, v1
    v_lshrrev_b32 v3, 4, v1
    v_lshlrev_b32 v4, 16, v3
    v_lshlrev_b32 v5, 2, v2
    v_add_u32 v7, v4, v5
    v_add_u32 v8, 8192, v7
    v_add_u32 v9, 16384, v7
    v_add_u32 v10, 24576, v7
    v_add_u32 v11, 32768, v7
    v_add_u32 v12, 40960, v7
    v_add_u32 v13, 49152, v7
    v_add_u32 v14, 57344, v7
    v_lshlrev_b32 v4, 10, v2
    v_lshlrev_b32 v5, 4, v3
    v_add_u32 v15, v4, v5
    v_add_u32 v16, 16384, v15
    s_and_b32 s25, s2, 7
    s_lshl_b32 s25, s25, 4
    s_lshr_b32 s26, s2, 3
    s_add_u32 s31, s25, s26
    s_waitcnt lgkmcnt(0)
    s_mov_b32 s12, s4
    s_mov_b32 s13, s5
    s_mov_b32 s14, 32768
    s_mov_b32 s15, 0x00020000
    s_mov_b32 s16, s6
    s_mov_b32 s17, s7
    s_mov_b32 s18, 4194304
    s_mov_b32 s19, 0x00020000
    s_mov_b32 s20, s8
    s_mov_b32 s21, s9
    s_mov_b32 s22, 16777216
    s_mov_b32 s23, 0x00020000
    s_lshl_b32 s25, s31, 6
    s_lshl_b32 s26, s24, 20
    s_add_u32 s29, s25, s26
    s_lshl_b32 s30, s24, 8
    s_mov_b32 s27, 0x05040100
    s_mov_b32 s28, 0x07060302
    buffer_load_dwordx4 v[44:47], v15, s[12:15], s30 offen offset:0
    buffer_load_dwordx4 v[48:51], v16, s[12:15], s30 offen offset:0
    buffer_load_dwordx4 v[52:55], v15, s[12:15], s30 offen offset:64
    buffer_load_dwordx4 v[56:59], v16, s[12:15], s30 offen offset:64
    buffer_load_dwordx4 v[60:63], v15, s[12:15], s30 offen offset:128
    buffer_load_dwordx4 v[64:67], v16, s[12:15], s30 offen offset:128
    buffer_load_dwordx4 v[68:71], v15, s[12:15], s30 offen offset:192
    buffer_load_dwordx4 v[72:75], v16, s[12:15], s30 offen offset:192
    buffer_load_dword v76, v7, s[16:19], s29 offen nt
    buffer_load_dword v77, v8, s[16:19], s29 offen nt
    buffer_load_dword v78, v9, s[16:19], s29 offen nt
    buffer_load_dword v79, v10, s[16:19], s29 offen nt
    buffer_load_dword v80, v11, s[16:19], s29 offen nt
    buffer_load_dword v81, v12, s[16:19], s29 offen nt
    buffer_load_dword v82, v13, s[16:19], s29 offen nt
    buffer_load_dword v83, v14, s[16:19], s29 offen nt
    s_add_u32 s29, s29, 262144
    buffer_load_dword v84, v7, s[16:19], s29 offen nt
    buffer_load_dword v85, v8, s[16:19], s29 offen nt
    buffer_load_dword v86, v9, s[16:19], s29 offen nt
    buffer_load_dword v87, v10, s[16:19], s29 offen nt
    buffer_load_dword v88, v11, s[16:19], s29 offen nt
    buffer_load_dword v89, v12, s[16:19], s29 offen nt
    buffer_load_dword v90, v13, s[16:19], s29 offen nt
    buffer_load_dword v91, v14, s[16:19], s29 offen nt
    s_add_u32 s29, s29, 262144
    buffer_load_dword v92, v7, s[16:19], s29 offen nt
    buffer_load_dword v93, v8, s[16:19], s29 offen nt
    buffer_load_dword v94, v9, s[16:19], s29 offen nt
    buffer_load_dword v95, v10, s[16:19], s29 offen nt
    buffer_load_dword v96, v11, s[16:19], s29 offen nt
    buffer_load_dword v97, v12, s[16:19], s29 offen nt
    buffer_load_dword v98, v13, s[16:19], s29 offen nt
    buffer_load_dword v99, v14, s[16:19], s29 offen nt
    s_add_u32 s29, s29, 262144
    buffer_load_dword v100, v7, s[16:19], s29 offen nt
    buffer_load_dword v101, v8, s[16:19], s29 offen nt
    buffer_load_dword v102, v9, s[16:19], s29 offen nt
    buffer_load_dword v103, v10, s[16:19], s29 offen nt
    buffer_load_dword v104, v11, s[16:19], s29 offen nt
    buffer_load_dword v105, v12, s[16:19], s29 offen nt
    buffer_load_dword v106, v13, s[16:19], s29 offen nt
    buffer_load_dword v107, v14, s[16:19], s29 offen nt
    s_waitcnt vmcnt(24)
    v_perm_b32 v20, v77, v76, s27
    v_perm_b32 v21, v79, v78, s27
    v_perm_b32 v22, v81, v80, s27
    v_perm_b32 v23, v83, v82, s27
    v_perm_b32 v24, v77, v76, s28
    v_perm_b32 v25, v79, v78, s28
    v_perm_b32 v26, v81, v80, s28
    v_perm_b32 v27, v83, v82, s28
    v_mfma_f32_16x16x32_bf16 v[28:31], v[44:47], v[20:23], 0
    v_mfma_f32_16x16x32_bf16 v[36:39], v[48:51], v[20:23], 0
    v_mfma_f32_16x16x32_bf16 v[32:35], v[44:47], v[24:27], 0
    v_mfma_f32_16x16x32_bf16 v[40:43], v[48:51], v[24:27], 0
    s_waitcnt vmcnt(16)
    v_perm_b32 v20, v85, v84, s27
    v_perm_b32 v21, v87, v86, s27
    v_perm_b32 v22, v89, v88, s27
    v_perm_b32 v23, v91, v90, s27
    v_perm_b32 v24, v85, v84, s28
    v_perm_b32 v25, v87, v86, s28
    v_perm_b32 v26, v89, v88, s28
    v_perm_b32 v27, v91, v90, s28
    v_mfma_f32_16x16x32_bf16 v[28:31], v[52:55], v[20:23], v[28:31]
    v_mfma_f32_16x16x32_bf16 v[36:39], v[56:59], v[20:23], v[36:39]
    v_mfma_f32_16x16x32_bf16 v[32:35], v[52:55], v[24:27], v[32:35]
    v_mfma_f32_16x16x32_bf16 v[40:43], v[56:59], v[24:27], v[40:43]
    s_waitcnt vmcnt(8)
    v_perm_b32 v20, v93, v92, s27
    v_perm_b32 v21, v95, v94, s27
    v_perm_b32 v22, v97, v96, s27
    v_perm_b32 v23, v99, v98, s27
    v_perm_b32 v24, v93, v92, s28
    v_perm_b32 v25, v95, v94, s28
    v_perm_b32 v26, v97, v96, s28
    v_perm_b32 v27, v99, v98, s28
    v_mfma_f32_16x16x32_bf16 v[28:31], v[60:63], v[20:23], v[28:31]
    v_mfma_f32_16x16x32_bf16 v[36:39], v[64:67], v[20:23], v[36:39]
    v_mfma_f32_16x16x32_bf16 v[32:35], v[60:63], v[24:27], v[32:35]
    v_mfma_f32_16x16x32_bf16 v[40:43], v[64:67], v[24:27], v[40:43]
    s_waitcnt vmcnt(0)
    v_perm_b32 v20, v101, v100, s27
    v_perm_b32 v21, v103, v102, s27
    v_perm_b32 v22, v105, v104, s27
    v_perm_b32 v23, v107, v106, s27
    v_perm_b32 v24, v101, v100, s28
    v_perm_b32 v25, v103, v102, s28
    v_perm_b32 v26, v105, v104, s28
    v_perm_b32 v27, v107, v106, s28
    v_mfma_f32_16x16x32_bf16 v[28:31], v[68:71], v[20:23], v[28:31]
    v_mfma_f32_16x16x32_bf16 v[36:39], v[72:75], v[20:23], v[36:39]
    v_mfma_f32_16x16x32_bf16 v[32:35], v[68:71], v[24:27], v[32:35]
    v_mfma_f32_16x16x32_bf16 v[40:43], v[72:75], v[24:27], v[40:43]
    s_nop 7
    s_lshl_b32 s25, s24, 12
    v_lshlrev_b32 v4, 4, v1
    v_add_u32 v6, s25, v4
    ds_write_b128 v6, v[28:31] offset:0
    ds_write_b128 v6, v[32:35] offset:1024
    ds_write_b128 v6, v[36:39] offset:2048
    ds_write_b128 v6, v[40:43] offset:3072
    s_waitcnt lgkmcnt(0)
    s_barrier
    s_lshr_b32 s25, s24, 1
    s_lshl_b32 s25, s25, 11
    s_and_b32 s26, s24, 1
    s_lshl_b32 s26, s26, 3
    s_add_u32 s25, s25, s26
    v_add_u32 v6, s25, v4
    ds_read_b64 v[108:109], v6 offset:0
    ds_read_b64 v[110:111], v6 offset:1024
    ds_read_b64 v[112:113], v6 offset:4096
    ds_read_b64 v[114:115], v6 offset:5120
    ds_read_b64 v[116:117], v6 offset:8192
    ds_read_b64 v[118:119], v6 offset:9216
    ds_read_b64 v[120:121], v6 offset:12288
    ds_read_b64 v[122:123], v6 offset:13312
    s_waitcnt lgkmcnt(0)
    v_add_f32 v108, v108, v112
    v_add_f32 v109, v109, v113
    v_add_f32 v110, v110, v114
    v_add_f32 v111, v111, v115
    v_add_f32 v108, v108, v116
    v_add_f32 v109, v109, v117
    v_add_f32 v110, v110, v118
    v_add_f32 v111, v111, v119
    v_add_f32 v108, v108, v120
    v_add_f32 v109, v109, v121
    v_add_f32 v110, v110, v122
    v_add_f32 v111, v111, v123
    v_cvt_pk_bf16_f32 v124, v108, v110
    v_cvt_pk_bf16_f32 v125, v109, v111
    v_lshlrev_b32 v4, 15, v3
    v_lshlrev_b32 v5, 2, v2
    v_add_u32 v4, v4, v5
    v_add_u32 v5, 8192, v4
    s_lshr_b32 s25, s24, 1
    s_lshl_b32 s25, s25, 17
    s_and_b32 s26, s24, 1
    s_lshl_b32 s26, s26, 14
    s_add_u32 s25, s25, s26
    s_lshl_b32 s26, s31, 6
    s_add_u32 s25, s25, s26
    buffer_store_dword v124, v4, s[20:23], s25 offen
    buffer_store_dword v125, v5, s[20:23], s25 offen
qproj_kernel_end:
    s_endpgm

.globl attn_kernel
.p2align 8
.type attn_kernel,@function
attn_kernel:
    s_cmp_ge_u32 s2, 256
    s_cbranch_scc1 attn_kernel_end
    s_load_dwordx4 s[4:7], s[0:1], 8
    s_load_dwordx2 s[8:9], s[0:1], 56
    v_lshrrev_b32 v4, 6, v0
    v_and_b32 v1, 63, v0
    v_readfirstlane_b32 s24, v4
    v_and_b32 v2, 15, v1
    v_lshrrev_b32 v3, 4, v1
    v_and_b32 v4, 3, v2
    v_lshlrev_b32 v4, 10, v4
    v_lshrrev_b32 v5, 2, v2
    v_lshlrev_b32 v5, 8, v5
    v_add_u32 v4, v4, v5
    v_lshlrev_b32 v6, 4, v3
    v_add_u32 v7, v4, v6
    v_add_u32 v8, 4096, v7
    v_lshlrev_b32 v9, 4, v1
    v_add_u32 v10, 4096, v9
    v_and_b32 v4, 3, v2
    v_lshlrev_b32 v4, 13, v4
    v_add_u32 v4, v4, v5
    v_add_u32 v11, v4, v6
    s_lshr_b32 s31, s2, 2
    s_and_b32 s33, s2, 3
    s_lshl_b32 s32, s31, 20
    s_lshl_b32 s33, s33, 18
    s_add_u32 s32, s32, s33
    s_waitcnt lgkmcnt(0)
    s_lshl_b32 s33, s24, 16
    s_add_u32 s32, s32, s33
    s_add_u32 s12, s4, s32
    s_addc_u32 s13, s5, 0
    s_mov_b32 s14, 65536
    s_mov_b32 s15, 0x00020000
    s_add_u32 s16, s6, s32
    s_addc_u32 s17, s7, 0
    s_mov_b32 s18, 65536
    s_mov_b32 s19, 0x00020000
    s_mov_b32 s20, s8
    s_mov_b32 s21, s9
    s_mov_b32 s22, 16777216
    s_mov_b32 s23, 0x00020000
    s_lshr_b32 s32, s31, 3
    s_lshl_b32 s32, s32, 15
    s_and_b32 s33, s31, 7
    s_lshl_b32 s33, s33, 10
    s_add_u32 s30, s32, s33
    buffer_load_dwordx4 v[20:23], v11, s[20:23], s30 offen offset:0
    buffer_load_dwordx4 v[24:27], v11, s[20:23], s30 offen offset:64
    buffer_load_dwordx4 v[28:31], v11, s[20:23], s30 offen offset:128
    buffer_load_dwordx4 v[32:35], v11, s[20:23], s30 offen offset:192
    s_mov_b32 s25, 0
    s_mov_b32 s27, 0x3e0293ee
    s_mov_b32 s28, 0x05040100
    s_mov_b32 s29, 0x07060302
    buffer_load_dwordx4 v[88:91], v7, s[12:15], s25 offen offset:0 nt
    buffer_load_dwordx4 v[92:95], v7, s[12:15], s25 offen offset:64 nt
    buffer_load_dwordx4 v[96:99], v7, s[12:15], s25 offen offset:128 nt
    buffer_load_dwordx4 v[100:103], v7, s[12:15], s25 offen offset:192 nt
    buffer_load_dwordx4 v[104:107], v8, s[12:15], s25 offen offset:0 nt
    buffer_load_dwordx4 v[108:111], v8, s[12:15], s25 offen offset:64 nt
    buffer_load_dwordx4 v[112:115], v8, s[12:15], s25 offen offset:128 nt
    buffer_load_dwordx4 v[116:119], v8, s[12:15], s25 offen offset:192 nt
    buffer_load_dwordx4 v[152:155], v9, s[16:19], s25 offen offset:0 nt
    buffer_load_dwordx4 v[156:159], v9, s[16:19], s25 offen offset:1024 nt
    buffer_load_dwordx4 v[160:163], v9, s[16:19], s25 offen offset:2048 nt
    buffer_load_dwordx4 v[164:167], v9, s[16:19], s25 offen offset:3072 nt
    buffer_load_dwordx4 v[168:171], v10, s[16:19], s25 offen offset:0 nt
    buffer_load_dwordx4 v[172:175], v10, s[16:19], s25 offen offset:1024 nt
    buffer_load_dwordx4 v[176:179], v10, s[16:19], s25 offen offset:2048 nt
    buffer_load_dwordx4 v[180:183], v10, s[16:19], s25 offen offset:3072 nt
    s_add_u32 s25, s25, 8192
    buffer_load_dwordx4 v[120:123], v7, s[12:15], s25 offen offset:0 nt
    buffer_load_dwordx4 v[124:127], v7, s[12:15], s25 offen offset:64 nt
    buffer_load_dwordx4 v[128:131], v7, s[12:15], s25 offen offset:128 nt
    buffer_load_dwordx4 v[132:135], v7, s[12:15], s25 offen offset:192 nt
    buffer_load_dwordx4 v[136:139], v8, s[12:15], s25 offen offset:0 nt
    buffer_load_dwordx4 v[140:143], v8, s[12:15], s25 offen offset:64 nt
    buffer_load_dwordx4 v[144:147], v8, s[12:15], s25 offen offset:128 nt
    buffer_load_dwordx4 v[148:151], v8, s[12:15], s25 offen offset:192 nt
    buffer_load_dwordx4 v[184:187], v9, s[16:19], s25 offen offset:0 nt
    buffer_load_dwordx4 v[188:191], v9, s[16:19], s25 offen offset:1024 nt
    buffer_load_dwordx4 v[192:195], v9, s[16:19], s25 offen offset:2048 nt
    buffer_load_dwordx4 v[196:199], v9, s[16:19], s25 offen offset:3072 nt
    buffer_load_dwordx4 v[200:203], v10, s[16:19], s25 offen offset:0 nt
    buffer_load_dwordx4 v[204:207], v10, s[16:19], s25 offen offset:1024 nt
    buffer_load_dwordx4 v[208:211], v10, s[16:19], s25 offen offset:2048 nt
    buffer_load_dwordx4 v[212:215], v10, s[16:19], s25 offen offset:3072 nt
    s_add_u32 s25, s25, 8192
    v_mov_b32 v12, 0xff800000
    v_mov_b32 v13, 0
    v_mov_b32 v56, 0
    v_mov_b32 v57, 0
    v_mov_b32 v58, 0
    v_mov_b32 v59, 0
    v_mov_b32 v60, 0
    v_mov_b32 v61, 0
    v_mov_b32 v62, 0
    v_mov_b32 v63, 0
    v_mov_b32 v64, 0
    v_mov_b32 v65, 0
    v_mov_b32 v66, 0
    v_mov_b32 v67, 0
    v_mov_b32 v68, 0
    v_mov_b32 v69, 0
    v_mov_b32 v70, 0
    v_mov_b32 v71, 0
    v_mov_b32 v72, 0
    v_mov_b32 v73, 0
    v_mov_b32 v74, 0
    v_mov_b32 v75, 0
    v_mov_b32 v76, 0
    v_mov_b32 v77, 0
    v_mov_b32 v78, 0
    v_mov_b32 v79, 0
    v_mov_b32 v80, 0
    v_mov_b32 v81, 0
    v_mov_b32 v82, 0
    v_mov_b32 v83, 0
    v_mov_b32 v84, 0
    v_mov_b32 v85, 0
    v_mov_b32 v86, 0
    v_mov_b32 v87, 0
    s_mov_b32 s26, 4
attn_kernel_loop:
    s_waitcnt vmcnt(24)
    v_mfma_f32_16x16x32_bf16 v[36:39], v[88:91], v[20:23], 0
    v_mfma_f32_16x16x32_bf16 v[40:43], v[104:107], v[20:23], 0
    v_mfma_f32_16x16x32_bf16 v[36:39], v[92:95], v[24:27], v[36:39]
    v_mfma_f32_16x16x32_bf16 v[40:43], v[108:111], v[24:27], v[40:43]
    v_mfma_f32_16x16x32_bf16 v[36:39], v[96:99], v[28:31], v[36:39]
    v_mfma_f32_16x16x32_bf16 v[40:43], v[112:115], v[28:31], v[40:43]
    v_mfma_f32_16x16x32_bf16 v[36:39], v[100:103], v[32:35], v[36:39]
    v_mfma_f32_16x16x32_bf16 v[40:43], v[116:119], v[32:35], v[40:43]
    buffer_load_dwordx4 v[88:91], v7, s[12:15], s25 offen offset:0 nt
    buffer_load_dwordx4 v[92:95], v7, s[12:15], s25 offen offset:64 nt
    buffer_load_dwordx4 v[96:99], v7, s[12:15], s25 offen offset:128 nt
    buffer_load_dwordx4 v[100:103], v7, s[12:15], s25 offen offset:192 nt
    buffer_load_dwordx4 v[104:107], v8, s[12:15], s25 offen offset:0 nt
    buffer_load_dwordx4 v[108:111], v8, s[12:15], s25 offen offset:64 nt
    buffer_load_dwordx4 v[112:115], v8, s[12:15], s25 offen offset:128 nt
    buffer_load_dwordx4 v[116:119], v8, s[12:15], s25 offen offset:192 nt
    v_max3_f32 v4, v36, v37, v38
    v_max3_f32 v4, v4, v39, v40
    v_max3_f32 v4, v4, v41, v42
    v_max_f32 v4, v4, v43
    v_mov_b32 v5, v4
    s_nop 1
    v_permlane32_swap_b32 v4, v5
    v_max_f32 v4, v4, v5
    v_mov_b32 v5, v4
    s_nop 1
    v_permlane16_swap_b32 v4, v5
    v_max_f32 v4, v4, v5
    v_max_f32 v14, v12, v4
    v_sub_f32 v5, v12, v14
    v_mul_f32 v5, s27, v5
    v_exp_f32 v15, v5
    v_mul_f32 v16, s27, v14
    v_mov_b32 v12, v14
    v_fma_f32 v36, v36, s27, -v16
    v_fma_f32 v37, v37, s27, -v16
    v_fma_f32 v38, v38, s27, -v16
    v_fma_f32 v39, v39, s27, -v16
    v_fma_f32 v40, v40, s27, -v16
    v_fma_f32 v41, v41, s27, -v16
    v_fma_f32 v42, v42, s27, -v16
    v_fma_f32 v43, v43, s27, -v16
    v_exp_f32 v36, v36
    v_exp_f32 v37, v37
    v_exp_f32 v38, v38
    v_exp_f32 v39, v39
    v_exp_f32 v40, v40
    v_exp_f32 v41, v41
    v_exp_f32 v42, v42
    v_exp_f32 v43, v43
    v_mul_f32 v56, v56, v15
    v_mul_f32 v57, v57, v15
    v_mul_f32 v58, v58, v15
    v_mul_f32 v59, v59, v15
    v_mul_f32 v60, v60, v15
    v_mul_f32 v61, v61, v15
    v_mul_f32 v62, v62, v15
    v_mul_f32 v63, v63, v15
    v_mul_f32 v64, v64, v15
    v_mul_f32 v65, v65, v15
    v_mul_f32 v66, v66, v15
    v_mul_f32 v67, v67, v15
    v_mul_f32 v68, v68, v15
    v_mul_f32 v69, v69, v15
    v_mul_f32 v70, v70, v15
    v_mul_f32 v71, v71, v15
    v_mul_f32 v72, v72, v15
    v_mul_f32 v73, v73, v15
    v_mul_f32 v74, v74, v15
    v_mul_f32 v75, v75, v15
    v_mul_f32 v76, v76, v15
    v_mul_f32 v77, v77, v15
    v_mul_f32 v78, v78, v15
    v_mul_f32 v79, v79, v15
    v_mul_f32 v80, v80, v15
    v_mul_f32 v81, v81, v15
    v_mul_f32 v82, v82, v15
    v_mul_f32 v83, v83, v15
    v_mul_f32 v84, v84, v15
    v_mul_f32 v85, v85, v15
    v_mul_f32 v86, v86, v15
    v_mul_f32 v87, v87, v15
    v_add_f32 v4, v36, v37
    v_add_f32 v5, v38, v39
    v_add_f32 v6, v40, v41
    v_add_f32 v4, v4, v5
    v_add_f32 v5, v42, v43
    v_add_f32 v6, v6, v5
    v_add_f32 v4, v4, v6
    v_fma_f32 v13, v13, v15, v4
    v_cvt_pk_bf16_f32 v44, v36, v37
    v_cvt_pk_bf16_f32 v45, v38, v39
    v_cvt_pk_bf16_f32 v46, v40, v41
    v_cvt_pk_bf16_f32 v47, v42, v43
    s_waitcnt vmcnt(24)
    v_perm_b32 v48, v156, v152, s28
    v_perm_b32 v49, v164, v160, s28
    v_perm_b32 v50, v172, v168, s28
    v_perm_b32 v51, v180, v176, s28
    v_perm_b32 v52, v156, v152, s29
    v_perm_b32 v53, v164, v160, s29
    v_perm_b32 v54, v172, v168, s29
    v_perm_b32 v55, v180, v176, s29
    v_mfma_f32_16x16x32_bf16 v[56:59], v[48:51], v[44:47], v[56:59]
    v_perm_b32 v48, v157, v153, s28
    v_perm_b32 v49, v165, v161, s28
    v_perm_b32 v50, v173, v169, s28
    v_perm_b32 v51, v181, v177, s28
    v_mfma_f32_16x16x32_bf16 v[60:63], v[52:55], v[44:47], v[60:63]
    v_perm_b32 v52, v157, v153, s29
    v_perm_b32 v53, v165, v161, s29
    v_perm_b32 v54, v173, v169, s29
    v_perm_b32 v55, v181, v177, s29
    v_mfma_f32_16x16x32_bf16 v[64:67], v[48:51], v[44:47], v[64:67]
    v_perm_b32 v48, v158, v154, s28
    v_perm_b32 v49, v166, v162, s28
    v_perm_b32 v50, v174, v170, s28
    v_perm_b32 v51, v182, v178, s28
    v_mfma_f32_16x16x32_bf16 v[68:71], v[52:55], v[44:47], v[68:71]
    v_perm_b32 v52, v158, v154, s29
    v_perm_b32 v53, v166, v162, s29
    v_perm_b32 v54, v174, v170, s29
    v_perm_b32 v55, v182, v178, s29
    v_mfma_f32_16x16x32_bf16 v[72:75], v[48:51], v[44:47], v[72:75]
    v_perm_b32 v48, v159, v155, s28
    v_perm_b32 v49, v167, v163, s28
    v_perm_b32 v50, v175, v171, s28
    v_perm_b32 v51, v183, v179, s28
    v_mfma_f32_16x16x32_bf16 v[76:79], v[52:55], v[44:47], v[76:79]
    v_perm_b32 v52, v159, v155, s29
    v_perm_b32 v53, v167, v163, s29
    v_perm_b32 v54, v175, v171, s29
    v_perm_b32 v55, v183, v179, s29
    v_mfma_f32_16x16x32_bf16 v[80:83], v[48:51], v[44:47], v[80:83]
    buffer_load_dwordx4 v[152:155], v9, s[16:19], s25 offen offset:0 nt
    buffer_load_dwordx4 v[156:159], v9, s[16:19], s25 offen offset:1024 nt
    buffer_load_dwordx4 v[160:163], v9, s[16:19], s25 offen offset:2048 nt
    buffer_load_dwordx4 v[164:167], v9, s[16:19], s25 offen offset:3072 nt
    buffer_load_dwordx4 v[168:171], v10, s[16:19], s25 offen offset:0 nt
    buffer_load_dwordx4 v[172:175], v10, s[16:19], s25 offen offset:1024 nt
    buffer_load_dwordx4 v[176:179], v10, s[16:19], s25 offen offset:2048 nt
    buffer_load_dwordx4 v[180:183], v10, s[16:19], s25 offen offset:3072 nt
    v_mfma_f32_16x16x32_bf16 v[84:87], v[52:55], v[44:47], v[84:87]
    s_add_u32 s25, s25, 8192
    s_waitcnt vmcnt(24)
    v_mfma_f32_16x16x32_bf16 v[36:39], v[120:123], v[20:23], 0
    v_mfma_f32_16x16x32_bf16 v[40:43], v[136:139], v[20:23], 0
    v_mfma_f32_16x16x32_bf16 v[36:39], v[124:127], v[24:27], v[36:39]
    v_mfma_f32_16x16x32_bf16 v[40:43], v[140:143], v[24:27], v[40:43]
    v_mfma_f32_16x16x32_bf16 v[36:39], v[128:131], v[28:31], v[36:39]
    v_mfma_f32_16x16x32_bf16 v[40:43], v[144:147], v[28:31], v[40:43]
    v_mfma_f32_16x16x32_bf16 v[36:39], v[132:135], v[32:35], v[36:39]
    v_mfma_f32_16x16x32_bf16 v[40:43], v[148:151], v[32:35], v[40:43]
    buffer_load_dwordx4 v[120:123], v7, s[12:15], s25 offen offset:0 nt
    buffer_load_dwordx4 v[124:127], v7, s[12:15], s25 offen offset:64 nt
    buffer_load_dwordx4 v[128:131], v7, s[12:15], s25 offen offset:128 nt
    buffer_load_dwordx4 v[132:135], v7, s[12:15], s25 offen offset:192 nt
    buffer_load_dwordx4 v[136:139], v8, s[12:15], s25 offen offset:0 nt
    buffer_load_dwordx4 v[140:143], v8, s[12:15], s25 offen offset:64 nt
    buffer_load_dwordx4 v[144:147], v8, s[12:15], s25 offen offset:128 nt
    buffer_load_dwordx4 v[148:151], v8, s[12:15], s25 offen offset:192 nt
    v_max3_f32 v4, v36, v37, v38
    v_max3_f32 v4, v4, v39, v40
    v_max3_f32 v4, v4, v41, v42
    v_max_f32 v4, v4, v43
    v_mov_b32 v5, v4
    s_nop 1
    v_permlane32_swap_b32 v4, v5
    v_max_f32 v4, v4, v5
    v_mov_b32 v5, v4
    s_nop 1
    v_permlane16_swap_b32 v4, v5
    v_max_f32 v4, v4, v5
    v_max_f32 v14, v12, v4
    v_sub_f32 v5, v12, v14
    v_mul_f32 v5, s27, v5
    v_exp_f32 v15, v5
    v_mul_f32 v16, s27, v14
    v_mov_b32 v12, v14
    v_fma_f32 v36, v36, s27, -v16
    v_fma_f32 v37, v37, s27, -v16
    v_fma_f32 v38, v38, s27, -v16
    v_fma_f32 v39, v39, s27, -v16
    v_fma_f32 v40, v40, s27, -v16
    v_fma_f32 v41, v41, s27, -v16
    v_fma_f32 v42, v42, s27, -v16
    v_fma_f32 v43, v43, s27, -v16
    v_exp_f32 v36, v36
    v_exp_f32 v37, v37
    v_exp_f32 v38, v38
    v_exp_f32 v39, v39
    v_exp_f32 v40, v40
    v_exp_f32 v41, v41
    v_exp_f32 v42, v42
    v_exp_f32 v43, v43
    v_mul_f32 v56, v56, v15
    v_mul_f32 v57, v57, v15
    v_mul_f32 v58, v58, v15
    v_mul_f32 v59, v59, v15
    v_mul_f32 v60, v60, v15
    v_mul_f32 v61, v61, v15
    v_mul_f32 v62, v62, v15
    v_mul_f32 v63, v63, v15
    v_mul_f32 v64, v64, v15
    v_mul_f32 v65, v65, v15
    v_mul_f32 v66, v66, v15
    v_mul_f32 v67, v67, v15
    v_mul_f32 v68, v68, v15
    v_mul_f32 v69, v69, v15
    v_mul_f32 v70, v70, v15
    v_mul_f32 v71, v71, v15
    v_mul_f32 v72, v72, v15
    v_mul_f32 v73, v73, v15
    v_mul_f32 v74, v74, v15
    v_mul_f32 v75, v75, v15
    v_mul_f32 v76, v76, v15
    v_mul_f32 v77, v77, v15
    v_mul_f32 v78, v78, v15
    v_mul_f32 v79, v79, v15
    v_mul_f32 v80, v80, v15
    v_mul_f32 v81, v81, v15
    v_mul_f32 v82, v82, v15
    v_mul_f32 v83, v83, v15
    v_mul_f32 v84, v84, v15
    v_mul_f32 v85, v85, v15
    v_mul_f32 v86, v86, v15
    v_mul_f32 v87, v87, v15
    v_add_f32 v4, v36, v37
    v_add_f32 v5, v38, v39
    v_add_f32 v6, v40, v41
    v_add_f32 v4, v4, v5
    v_add_f32 v5, v42, v43
    v_add_f32 v6, v6, v5
    v_add_f32 v4, v4, v6
    v_fma_f32 v13, v13, v15, v4
    v_cvt_pk_bf16_f32 v44, v36, v37
    v_cvt_pk_bf16_f32 v45, v38, v39
    v_cvt_pk_bf16_f32 v46, v40, v41
    v_cvt_pk_bf16_f32 v47, v42, v43
    s_waitcnt vmcnt(24)
    v_perm_b32 v48, v188, v184, s28
    v_perm_b32 v49, v196, v192, s28
    v_perm_b32 v50, v204, v200, s28
    v_perm_b32 v51, v212, v208, s28
    v_perm_b32 v52, v188, v184, s29
    v_perm_b32 v53, v196, v192, s29
    v_perm_b32 v54, v204, v200, s29
    v_perm_b32 v55, v212, v208, s29
    v_mfma_f32_16x16x32_bf16 v[56:59], v[48:51], v[44:47], v[56:59]
    v_perm_b32 v48, v189, v185, s28
    v_perm_b32 v49, v197, v193, s28
    v_perm_b32 v50, v205, v201, s28
    v_perm_b32 v51, v213, v209, s28
    v_mfma_f32_16x16x32_bf16 v[60:63], v[52:55], v[44:47], v[60:63]
    v_perm_b32 v52, v189, v185, s29
    v_perm_b32 v53, v197, v193, s29
    v_perm_b32 v54, v205, v201, s29
    v_perm_b32 v55, v213, v209, s29
    v_mfma_f32_16x16x32_bf16 v[64:67], v[48:51], v[44:47], v[64:67]
    v_perm_b32 v48, v190, v186, s28
    v_perm_b32 v49, v198, v194, s28
    v_perm_b32 v50, v206, v202, s28
    v_perm_b32 v51, v214, v210, s28
    v_mfma_f32_16x16x32_bf16 v[68:71], v[52:55], v[44:47], v[68:71]
    v_perm_b32 v52, v190, v186, s29
    v_perm_b32 v53, v198, v194, s29
    v_perm_b32 v54, v206, v202, s29
    v_perm_b32 v55, v214, v210, s29
    v_mfma_f32_16x16x32_bf16 v[72:75], v[48:51], v[44:47], v[72:75]
    v_perm_b32 v48, v191, v187, s28
    v_perm_b32 v49, v199, v195, s28
    v_perm_b32 v50, v207, v203, s28
    v_perm_b32 v51, v215, v211, s28
    v_mfma_f32_16x16x32_bf16 v[76:79], v[52:55], v[44:47], v[76:79]
    v_perm_b32 v52, v191, v187, s29
    v_perm_b32 v53, v199, v195, s29
    v_perm_b32 v54, v207, v203, s29
    v_perm_b32 v55, v215, v211, s29
    v_mfma_f32_16x16x32_bf16 v[80:83], v[48:51], v[44:47], v[80:83]
    buffer_load_dwordx4 v[184:187], v9, s[16:19], s25 offen offset:0 nt
    buffer_load_dwordx4 v[188:191], v9, s[16:19], s25 offen offset:1024 nt
    buffer_load_dwordx4 v[192:195], v9, s[16:19], s25 offen offset:2048 nt
    buffer_load_dwordx4 v[196:199], v9, s[16:19], s25 offen offset:3072 nt
    buffer_load_dwordx4 v[200:203], v10, s[16:19], s25 offen offset:0 nt
    buffer_load_dwordx4 v[204:207], v10, s[16:19], s25 offen offset:1024 nt
    buffer_load_dwordx4 v[208:211], v10, s[16:19], s25 offen offset:2048 nt
    buffer_load_dwordx4 v[212:215], v10, s[16:19], s25 offen offset:3072 nt
    v_mfma_f32_16x16x32_bf16 v[84:87], v[52:55], v[44:47], v[84:87]
    s_add_u32 s25, s25, 8192
    s_sub_u32 s26, s26, 1
    s_cmp_lg_u32 s26, 0
    s_cbranch_scc1 attn_kernel_loop
    s_waitcnt vmcnt(0)
    v_mov_b32 v5, v13
    s_nop 1
    v_permlane32_swap_b32 v13, v5
    v_add_f32 v13, v13, v5
    v_mov_b32 v5, v13
    s_nop 1
    v_permlane16_swap_b32 v13, v5
    v_add_f32 v13, v13, v5
    s_lshl_b32 s32, s24, 13
    v_lshlrev_b32 v4, 4, v1
    v_add_u32 v6, s32, v4
    ds_write_b128 v6, v[56:59] offset:0
    ds_write_b128 v6, v[60:63] offset:1024
    ds_write_b128 v6, v[64:67] offset:2048
    ds_write_b128 v6, v[68:71] offset:3072
    ds_write_b128 v6, v[72:75] offset:4096
    ds_write_b128 v6, v[76:79] offset:5120
    ds_write_b128 v6, v[80:83] offset:6144
    ds_write_b128 v6, v[84:87] offset:7168
    s_lshl_b32 s32, s24, 7
    s_add_u32 s32, s32, 32768
    v_lshlrev_b32 v5, 3, v2
    v_add_u32 v14, s32, v5
    ds_write_b64 v14, v[12:13]
    s_waitcnt lgkmcnt(0)
    s_barrier
    v_add_u32 v14, 32768, v5
    ds_read_b64 v[88:89], v14 offset:0
    ds_read_b64 v[90:91], v14 offset:128
    ds_read_b64 v[92:93], v14 offset:256
    ds_read_b64 v[94:95], v14 offset:384
    s_lshl_b32 s32, s24, 11
    v_add_u32 v6, s32, v4
    ds_read_b128 v[96:99], v6 offset:0
    ds_read_b128 v[100:103], v6 offset:1024
    ds_read_b128 v[104:107], v6 offset:8192
    ds_read_b128 v[108:111], v6 offset:9216
    ds_read_b128 v[112:115], v6 offset:16384
    ds_read_b128 v[116:119], v6 offset:17408
    ds_read_b128 v[120:123], v6 offset:24576
    ds_read_b128 v[124:127], v6 offset:25600
    s_waitcnt lgkmcnt(8)
    v_max_f32 v14, v88, v90
    v_max_f32 v14, v14, v92
    v_max_f32 v14, v14, v94
    v_sub_f32 v36, v88, v14
    v_sub_f32 v37, v90, v14
    v_sub_f32 v38, v92, v14
    v_sub_f32 v39, v94, v14
    v_mul_f32 v36, s27, v36
    v_mul_f32 v37, s27, v37
    v_mul_f32 v38, s27, v38
    v_mul_f32 v39, s27, v39
    v_exp_f32 v36, v36
    v_exp_f32 v37, v37
    v_exp_f32 v38, v38
    v_exp_f32 v39, v39
    s_nop 0
    v_mul_f32 v15, v36, v89
    v_fma_f32 v15, v37, v91, v15
    v_fma_f32 v15, v38, v93, v15
    v_fma_f32 v15, v39, v95, v15
    s_waitcnt lgkmcnt(0)
    v_mul_f32 v56, v36, v96
    v_mul_f32 v57, v36, v97
    v_mul_f32 v58, v36, v98
    v_mul_f32 v59, v36, v99
    v_fma_f32 v56, v37, v104, v56
    v_fma_f32 v57, v37, v105, v57
    v_fma_f32 v58, v37, v106, v58
    v_fma_f32 v59, v37, v107, v59
    v_fma_f32 v56, v38, v112, v56
    v_fma_f32 v57, v38, v113, v57
    v_fma_f32 v58, v38, v114, v58
    v_fma_f32 v59, v38, v115, v59
    v_fma_f32 v56, v39, v120, v56
    v_fma_f32 v57, v39, v121, v57
    v_fma_f32 v58, v39, v122, v58
    v_fma_f32 v59, v39, v123, v59
    v_mul_f32 v60, v36, v100
    v_mul_f32 v61, v36, v101
    v_mul_f32 v62, v36, v102
    v_mul_f32 v63, v36, v103
    v_fma_f32 v60, v37, v108, v60
    v_fma_f32 v61, v37, v109, v61
    v_fma_f32 v62, v37, v110, v62
    v_fma_f32 v63, v37, v111, v63
    v_fma_f32 v60, v38, v116, v60
    v_fma_f32 v61, v38, v117, v61
    v_fma_f32 v62, v38, v118, v62
    v_fma_f32 v63, v38, v119, v63
    v_fma_f32 v60, v39, v124, v60
    v_fma_f32 v61, v39, v125, v61
    v_fma_f32 v62, v39, v126, v62
    v_fma_f32 v63, v39, v127, v63
    v_lshrrev_b32 v4, 2, v2
    v_lshlrev_b32 v4, 16, v4
    v_lshlrev_b32 v5, 14, v3
    v_add_u32 v4, v4, v5
    v_and_b32 v5, 3, v2
    v_lshlrev_b32 v5, 4, v5
    v_add_u32 v4, v4, v5
    s_and_b32 s32, s31, 7
    s_lshl_b32 s34, s32, 18
    s_lshr_b32 s32, s31, 5
    s_lshl_b32 s32, s32, 13
    s_add_u32 s34, s34, s32
    s_and_b32 s32, s2, 3
    s_lshl_b32 s32, s32, 11
    s_add_u32 s34, s34, s32
    s_lshl_b32 s32, s24, 8
    s_add_u32 s34, s34, s32
    s_lshr_b32 s32, s31, 3
    s_and_b32 s32, s32, 3
    s_lshl_b32 s32, s32, 6
    s_add_u32 s34, s34, s32
    s_add_u32 s34, s34, 262144
    buffer_store_dwordx4 v[56:59], v4, s[20:23], s34 offen offset:0
    buffer_store_dwordx4 v[60:63], v4, s[20:23], s34 offen offset:1024
    v_lshlrev_b32 v5, 3, v2
    s_cmp_lg_u32 s24, 0
    s_cbranch_scc1 attn_kernel_skipml
    v_mov_b32 v12, v14
    v_mov_b32 v13, v15
    s_lshl_b32 s34, s2, 7
    s_add_u32 s34, s34, 2359296
    buffer_store_dwordx2 v[12:13], v5, s[20:23], s34 offen
attn_kernel_skipml:
attn_kernel_end:
    s_endpgm

.globl oproj_kernel
.p2align 8
.type oproj_kernel,@function
oproj_kernel:
    s_cmp_ge_u32 s2, 128
    s_cbranch_scc1 oproj_kernel_end
    s_load_dwordx2 s[4:5], s[0:1], 32
    s_load_dwordx2 s[8:9], s[0:1], 56
    v_and_b32 v1, 15, v0
    v_lshrrev_b32 v2, 4, v0
    v_lshlrev_b32 v3, 11, v2
    v_lshlrev_b32 v4, 4, v1
    v_add_u32 v6, v3, v4
    v_add_u32 v7, 8192, v6
    v_add_u32 v8, 16384, v6
    v_add_u32 v9, 24576, v6
    v_lshlrev_b32 v10, 4, v0
    v_lshrrev_b32 v4, 2, v1
    v_lshlrev_b32 v4, 12, v4
    v_and_b32 v5, 3, v1
    v_lshlrev_b32 v5, 3, v5
    v_add_u32 v11, v4, v5
    v_add_u32 v12, 16384, v11
    s_lshr_b32 s40, s2, 2
    s_and_b32 s41, s40, 3
    s_lshr_b32 s42, s40, 2
    s_waitcnt lgkmcnt(0)
    s_mov_b32 s12, s4
    s_mov_b32 s13, s5
    s_mov_b32 s14, 4194304
    s_mov_b32 s15, 0x00020000
    s_mov_b32 s16, s8
    s_mov_b32 s17, s9
    s_mov_b32 s18, 16777216
    s_mov_b32 s19, 0x00020000
    s_lshl_b32 s25, s42, 9
    s_lshl_b32 s26, s41, 5
    s_add_u32 s30, s25, s26
    s_add_u32 s30, s30, 2359296
    buffer_load_dwordx2 v[42:43], v11, s[16:19], s30 offen offset:0
    buffer_load_dwordx2 v[44:45], v11, s[16:19], s30 offen offset:128
    buffer_load_dwordx2 v[46:47], v11, s[16:19], s30 offen offset:256
    buffer_load_dwordx2 v[48:49], v11, s[16:19], s30 offen offset:384
    buffer_load_dwordx2 v[50:51], v12, s[16:19], s30 offen offset:0
    buffer_load_dwordx2 v[52:53], v12, s[16:19], s30 offen offset:128
    buffer_load_dwordx2 v[54:55], v12, s[16:19], s30 offen offset:256
    buffer_load_dwordx2 v[56:57], v12, s[16:19], s30 offen offset:384
    s_lshl_b32 s25, s42, 18
    s_lshl_b32 s26, s41, 16
    s_add_u32 s32, s25, s26
    s_add_u32 s32, s32, 262144
    s_lshl_b32 s29, s40, 17
    s_and_b32 s26, s2, 3
    s_lshl_b32 s26, s26, 8
    s_add_u32 s29, s29, s26
    s_mov_b32 s31, 0x3e0293ee
    s_mov_b32 s27, 0x05040100
    s_mov_b32 s28, 0x07060302
    buffer_load_dwordx4 v[60:63], v6, s[12:15], s29 offen offset:0 nt
    buffer_load_dwordx4 v[64:67], v7, s[12:15], s29 offen offset:0 nt
    buffer_load_dwordx4 v[68:71], v8, s[12:15], s29 offen offset:0 nt
    buffer_load_dwordx4 v[72:75], v9, s[12:15], s29 offen offset:0 nt
    buffer_load_dwordx4 v[76:79], v6, s[12:15], s29 offen offset:1024 nt
    buffer_load_dwordx4 v[80:83], v7, s[12:15], s29 offen offset:1024 nt
    buffer_load_dwordx4 v[84:87], v8, s[12:15], s29 offen offset:1024 nt
    buffer_load_dwordx4 v[88:91], v9, s[12:15], s29 offen offset:1024 nt
    s_add_u32 s29, s29, 32768
    s_add_u32 s33, s32, 0
    s_add_u32 s34, s32, 4096
    s_add_u32 s35, s32, 8192
    s_add_u32 s36, s32, 12288
    buffer_load_dwordx4 v[124:127], v10, s[16:19], s33 offen offset:0
    buffer_load_dwordx4 v[128:131], v10, s[16:19], s33 offen offset:1024
    buffer_load_dwordx4 v[132:135], v10, s[16:19], s33 offen offset:2048
    buffer_load_dwordx4 v[136:139], v10, s[16:19], s33 offen offset:3072
    buffer_load_dwordx4 v[140:143], v10, s[16:19], s34 offen offset:0
    buffer_load_dwordx4 v[144:147], v10, s[16:19], s34 offen offset:1024
    buffer_load_dwordx4 v[148:151], v10, s[16:19], s34 offen offset:2048
    buffer_load_dwordx4 v[152:155], v10, s[16:19], s34 offen offset:3072
    buffer_load_dwordx4 v[156:159], v10, s[16:19], s35 offen offset:0
    buffer_load_dwordx4 v[160:163], v10, s[16:19], s35 offen offset:1024
    buffer_load_dwordx4 v[164:167], v10, s[16:19], s35 offen offset:2048
    buffer_load_dwordx4 v[168:171], v10, s[16:19], s35 offen offset:3072
    buffer_load_dwordx4 v[172:175], v10, s[16:19], s36 offen offset:0
    buffer_load_dwordx4 v[176:179], v10, s[16:19], s36 offen offset:1024
    buffer_load_dwordx4 v[180:183], v10, s[16:19], s36 offen offset:2048
    buffer_load_dwordx4 v[184:187], v10, s[16:19], s36 offen offset:3072
    s_add_u32 s32, s32, 16384
    buffer_load_dwordx4 v[92:95], v6, s[12:15], s29 offen offset:0 nt
    buffer_load_dwordx4 v[96:99], v7, s[12:15], s29 offen offset:0 nt
    buffer_load_dwordx4 v[100:103], v8, s[12:15], s29 offen offset:0 nt
    buffer_load_dwordx4 v[104:107], v9, s[12:15], s29 offen offset:0 nt
    buffer_load_dwordx4 v[108:111], v6, s[12:15], s29 offen offset:1024 nt
    buffer_load_dwordx4 v[112:115], v7, s[12:15], s29 offen offset:1024 nt
    buffer_load_dwordx4 v[116:119], v8, s[12:15], s29 offen offset:1024 nt
    buffer_load_dwordx4 v[120:123], v9, s[12:15], s29 offen offset:1024 nt
    s_add_u32 s29, s29, 32768
    s_add_u32 s33, s32, 0
    s_add_u32 s34, s32, 4096
    s_add_u32 s35, s32, 8192
    s_add_u32 s36, s32, 12288
    buffer_load_dwordx4 v[188:191], v10, s[16:19], s33 offen offset:0
    buffer_load_dwordx4 v[192:195], v10, s[16:19], s33 offen offset:1024
    buffer_load_dwordx4 v[196:199], v10, s[16:19], s33 offen offset:2048
    buffer_load_dwordx4 v[200:203], v10, s[16:19], s33 offen offset:3072
    buffer_load_dwordx4 v[204:207], v10, s[16:19], s34 offen offset:0
    buffer_load_dwordx4 v[208:211], v10, s[16:19], s34 offen offset:1024
    buffer_load_dwordx4 v[212:215], v10, s[16:19], s34 offen offset:2048
    buffer_load_dwordx4 v[216:219], v10, s[16:19], s34 offen offset:3072
    buffer_load_dwordx4 v[220:223], v10, s[16:19], s35 offen offset:0
    buffer_load_dwordx4 v[224:227], v10, s[16:19], s35 offen offset:1024
    buffer_load_dwordx4 v[228:231], v10, s[16:19], s35 offen offset:2048
    buffer_load_dwordx4 v[232:235], v10, s[16:19], s35 offen offset:3072
    buffer_load_dwordx4 v[236:239], v10, s[16:19], s36 offen offset:0
    buffer_load_dwordx4 v[240:243], v10, s[16:19], s36 offen offset:1024
    buffer_load_dwordx4 v[244:247], v10, s[16:19], s36 offen offset:2048
    buffer_load_dwordx4 v[248:251], v10, s[16:19], s36 offen offset:3072
    s_add_u32 s32, s32, 16384
    s_waitcnt vmcnt(48)
    v_max_f32 v40, v42, v44
    v_max3_f32 v40, v40, v46, v48
    v_sub_f32 v32, v42, v40
    v_sub_f32 v33, v44, v40
    v_sub_f32 v34, v46, v40
    v_sub_f32 v35, v48, v40
    v_mul_f32 v32, s31, v32
    v_mul_f32 v33, s31, v33
    v_mul_f32 v34, s31, v34
    v_mul_f32 v35, s31, v35
    v_exp_f32 v32, v32
    v_exp_f32 v33, v33
    v_exp_f32 v34, v34
    v_exp_f32 v35, v35
    s_nop 0
    v_mul_f32 v41, v32, v43
    v_fma_f32 v41, v33, v45, v41
    v_fma_f32 v41, v34, v47, v41
    v_fma_f32 v41, v35, v49, v41
    v_rcp_f32 v41, v41
    s_nop 0
    v_mul_f32 v32, v32, v41
    v_mul_f32 v33, v33, v41
    v_mul_f32 v34, v34, v41
    v_mul_f32 v35, v35, v41
    v_max_f32 v40, v50, v52
    v_max3_f32 v40, v40, v54, v56
    v_sub_f32 v36, v50, v40
    v_sub_f32 v37, v52, v40
    v_sub_f32 v38, v54, v40
    v_sub_f32 v39, v56, v40
    v_mul_f32 v36, s31, v36
    v_mul_f32 v37, s31, v37
    v_mul_f32 v38, s31, v38
    v_mul_f32 v39, s31, v39
    v_exp_f32 v36, v36
    v_exp_f32 v37, v37
    v_exp_f32 v38, v38
    v_exp_f32 v39, v39
    s_nop 0
    v_mul_f32 v41, v36, v51
    v_fma_f32 v41, v37, v53, v41
    v_fma_f32 v41, v38, v55, v41
    v_fma_f32 v41, v39, v57, v41
    v_rcp_f32 v41, v41
    s_nop 0
    v_mul_f32 v36, v36, v41
    v_mul_f32 v37, v37, v41
    v_mul_f32 v38, v38, v41
    v_mul_f32 v39, v39, v41
    s_waitcnt vmcnt(24)
    v_mul_f32 v124, v32, v124
    v_mul_f32 v125, v32, v125
    v_mul_f32 v126, v32, v126
    v_mul_f32 v127, v32, v127
    v_fma_f32 v124, v33, v132, v124
    v_fma_f32 v125, v33, v133, v125
    v_fma_f32 v126, v33, v134, v126
    v_fma_f32 v127, v33, v135, v127
    v_fma_f32 v124, v34, v140, v124
    v_fma_f32 v125, v34, v141, v125
    v_fma_f32 v126, v34, v142, v126
    v_fma_f32 v127, v34, v143, v127
    v_fma_f32 v124, v35, v148, v124
    v_fma_f32 v125, v35, v149, v125
    v_fma_f32 v126, v35, v150, v126
    v_fma_f32 v127, v35, v151, v127
    v_mul_f32 v128, v32, v128
    v_mul_f32 v129, v32, v129
    v_mul_f32 v130, v32, v130
    v_mul_f32 v131, v32, v131
    v_fma_f32 v128, v33, v136, v128
    v_fma_f32 v129, v33, v137, v129
    v_fma_f32 v130, v33, v138, v130
    v_fma_f32 v131, v33, v139, v131
    v_fma_f32 v128, v34, v144, v128
    v_fma_f32 v129, v34, v145, v129
    v_fma_f32 v130, v34, v146, v130
    v_fma_f32 v131, v34, v147, v131
    v_fma_f32 v128, v35, v152, v128
    v_fma_f32 v129, v35, v153, v129
    v_fma_f32 v130, v35, v154, v130
    v_fma_f32 v131, v35, v155, v131
    v_cvt_pk_bf16_f32 v24, v124, v125
    v_cvt_pk_bf16_f32 v25, v126, v127
    v_cvt_pk_bf16_f32 v26, v128, v129
    v_cvt_pk_bf16_f32 v27, v130, v131
    v_mul_f32 v156, v36, v156
    v_mul_f32 v157, v36, v157
    v_mul_f32 v158, v36, v158
    v_mul_f32 v159, v36, v159
    v_fma_f32 v156, v37, v164, v156
    v_fma_f32 v157, v37, v165, v157
    v_fma_f32 v158, v37, v166, v158
    v_fma_f32 v159, v37, v167, v159
    v_fma_f32 v156, v38, v172, v156
    v_fma_f32 v157, v38, v173, v157
    v_fma_f32 v158, v38, v174, v158
    v_fma_f32 v159, v38, v175, v159
    v_fma_f32 v156, v39, v180, v156
    v_fma_f32 v157, v39, v181, v157
    v_fma_f32 v158, v39, v182, v158
    v_fma_f32 v159, v39, v183, v159
    v_mul_f32 v160, v36, v160
    v_mul_f32 v161, v36, v161
    v_mul_f32 v162, v36, v162
    v_mul_f32 v163, v36, v163
    v_fma_f32 v160, v37, v168, v160
    v_fma_f32 v161, v37, v169, v161
    v_fma_f32 v162, v37, v170, v162
    v_fma_f32 v163, v37, v171, v163
    v_fma_f32 v160, v38, v176, v160
    v_fma_f32 v161, v38, v177, v161
    v_fma_f32 v162, v38, v178, v162
    v_fma_f32 v163, v38, v179, v163
    v_fma_f32 v160, v39, v184, v160
    v_fma_f32 v161, v39, v185, v161
    v_fma_f32 v162, v39, v186, v162
    v_fma_f32 v163, v39, v187, v163
    v_cvt_pk_bf16_f32 v28, v156, v157
    v_cvt_pk_bf16_f32 v29, v158, v159
    v_cvt_pk_bf16_f32 v30, v160, v161
    v_cvt_pk_bf16_f32 v31, v162, v163
    v_perm_b32 v16, v64, v60, s27
    v_perm_b32 v17, v72, v68, s27
    v_perm_b32 v18, v80, v76, s27
    v_perm_b32 v19, v88, v84, s27
    v_perm_b32 v20, v64, v60, s28
    v_perm_b32 v21, v72, v68, s28
    v_perm_b32 v22, v80, v76, s28
    v_perm_b32 v23, v88, v84, s28
    v_mfma_f32_16x16x32_bf16 a[0:3], v[24:27], v[16:19], 0
    v_mfma_f32_16x16x32_bf16 a[32:35], v[28:31], v[16:19], 0
    v_perm_b32 v16, v65, v61, s27
    v_perm_b32 v17, v73, v69, s27
    v_perm_b32 v18, v81, v77, s27
    v_perm_b32 v19, v89, v85, s27
    v_mfma_f32_16x16x32_bf16 a[4:7], v[24:27], v[20:23], 0
    v_mfma_f32_16x16x32_bf16 a[36:39], v[28:31], v[20:23], 0
    v_perm_b32 v20, v65, v61, s28
    v_perm_b32 v21, v73, v69, s28
    v_perm_b32 v22, v81, v77, s28
    v_perm_b32 v23, v89, v85, s28
    v_mfma_f32_16x16x32_bf16 a[8:11], v[24:27], v[16:19], 0
    v_mfma_f32_16x16x32_bf16 a[40:43], v[28:31], v[16:19], 0
    v_perm_b32 v16, v66, v62, s27
    v_perm_b32 v17, v74, v70, s27
    v_perm_b32 v18, v82, v78, s27
    v_perm_b32 v19, v90, v86, s27
    v_mfma_f32_16x16x32_bf16 a[12:15], v[24:27], v[20:23], 0
    v_mfma_f32_16x16x32_bf16 a[44:47], v[28:31], v[20:23], 0
    v_perm_b32 v20, v66, v62, s28
    v_perm_b32 v21, v74, v70, s28
    v_perm_b32 v22, v82, v78, s28
    v_perm_b32 v23, v90, v86, s28
    v_mfma_f32_16x16x32_bf16 a[16:19], v[24:27], v[16:19], 0
    v_mfma_f32_16x16x32_bf16 a[48:51], v[28:31], v[16:19], 0
    v_perm_b32 v16, v67, v63, s27
    v_perm_b32 v17, v75, v71, s27
    v_perm_b32 v18, v83, v79, s27
    v_perm_b32 v19, v91, v87, s27
    v_mfma_f32_16x16x32_bf16 a[20:23], v[24:27], v[20:23], 0
    v_mfma_f32_16x16x32_bf16 a[52:55], v[28:31], v[20:23], 0
    v_perm_b32 v20, v67, v63, s28
    v_perm_b32 v21, v75, v71, s28
    v_perm_b32 v22, v83, v79, s28
    v_perm_b32 v23, v91, v87, s28
    v_mfma_f32_16x16x32_bf16 a[24:27], v[24:27], v[16:19], 0
    v_mfma_f32_16x16x32_bf16 a[56:59], v[28:31], v[16:19], 0
    s_nop 0
    v_mfma_f32_16x16x32_bf16 a[28:31], v[24:27], v[20:23], 0
    v_mfma_f32_16x16x32_bf16 a[60:63], v[28:31], v[20:23], 0
    buffer_load_dwordx4 v[60:63], v6, s[12:15], s29 offen offset:0 nt
    buffer_load_dwordx4 v[64:67], v7, s[12:15], s29 offen offset:0 nt
    buffer_load_dwordx4 v[68:71], v8, s[12:15], s29 offen offset:0 nt
    buffer_load_dwordx4 v[72:75], v9, s[12:15], s29 offen offset:0 nt
    buffer_load_dwordx4 v[76:79], v6, s[12:15], s29 offen offset:1024 nt
    buffer_load_dwordx4 v[80:83], v7, s[12:15], s29 offen offset:1024 nt
    buffer_load_dwordx4 v[84:87], v8, s[12:15], s29 offen offset:1024 nt
    buffer_load_dwordx4 v[88:91], v9, s[12:15], s29 offen offset:1024 nt
    s_add_u32 s29, s29, 32768
    s_add_u32 s33, s32, 0
    s_add_u32 s34, s32, 4096
    s_add_u32 s35, s32, 8192
    s_add_u32 s36, s32, 12288
    buffer_load_dwordx4 v[124:127], v10, s[16:19], s33 offen offset:0
    buffer_load_dwordx4 v[128:131], v10, s[16:19], s33 offen offset:1024
    buffer_load_dwordx4 v[132:135], v10, s[16:19], s33 offen offset:2048
    buffer_load_dwordx4 v[136:139], v10, s[16:19], s33 offen offset:3072
    buffer_load_dwordx4 v[140:143], v10, s[16:19], s34 offen offset:0
    buffer_load_dwordx4 v[144:147], v10, s[16:19], s34 offen offset:1024
    buffer_load_dwordx4 v[148:151], v10, s[16:19], s34 offen offset:2048
    buffer_load_dwordx4 v[152:155], v10, s[16:19], s34 offen offset:3072
    buffer_load_dwordx4 v[156:159], v10, s[16:19], s35 offen offset:0
    buffer_load_dwordx4 v[160:163], v10, s[16:19], s35 offen offset:1024
    buffer_load_dwordx4 v[164:167], v10, s[16:19], s35 offen offset:2048
    buffer_load_dwordx4 v[168:171], v10, s[16:19], s35 offen offset:3072
    buffer_load_dwordx4 v[172:175], v10, s[16:19], s36 offen offset:0
    buffer_load_dwordx4 v[176:179], v10, s[16:19], s36 offen offset:1024
    buffer_load_dwordx4 v[180:183], v10, s[16:19], s36 offen offset:2048
    buffer_load_dwordx4 v[184:187], v10, s[16:19], s36 offen offset:3072
    s_add_u32 s32, s32, 16384
    s_waitcnt vmcnt(24)
    v_mul_f32 v188, v32, v188
    v_mul_f32 v189, v32, v189
    v_mul_f32 v190, v32, v190
    v_mul_f32 v191, v32, v191
    v_fma_f32 v188, v33, v196, v188
    v_fma_f32 v189, v33, v197, v189
    v_fma_f32 v190, v33, v198, v190
    v_fma_f32 v191, v33, v199, v191
    v_fma_f32 v188, v34, v204, v188
    v_fma_f32 v189, v34, v205, v189
    v_fma_f32 v190, v34, v206, v190
    v_fma_f32 v191, v34, v207, v191
    v_fma_f32 v188, v35, v212, v188
    v_fma_f32 v189, v35, v213, v189
    v_fma_f32 v190, v35, v214, v190
    v_fma_f32 v191, v35, v215, v191
    v_mul_f32 v192, v32, v192
    v_mul_f32 v193, v32, v193
    v_mul_f32 v194, v32, v194
    v_mul_f32 v195, v32, v195
    v_fma_f32 v192, v33, v200, v192
    v_fma_f32 v193, v33, v201, v193
    v_fma_f32 v194, v33, v202, v194
    v_fma_f32 v195, v33, v203, v195
    v_fma_f32 v192, v34, v208, v192
    v_fma_f32 v193, v34, v209, v193
    v_fma_f32 v194, v34, v210, v194
    v_fma_f32 v195, v34, v211, v195
    v_fma_f32 v192, v35, v216, v192
    v_fma_f32 v193, v35, v217, v193
    v_fma_f32 v194, v35, v218, v194
    v_fma_f32 v195, v35, v219, v195
    v_cvt_pk_bf16_f32 v24, v188, v189
    v_cvt_pk_bf16_f32 v25, v190, v191
    v_cvt_pk_bf16_f32 v26, v192, v193
    v_cvt_pk_bf16_f32 v27, v194, v195
    v_mul_f32 v220, v36, v220
    v_mul_f32 v221, v36, v221
    v_mul_f32 v222, v36, v222
    v_mul_f32 v223, v36, v223
    v_fma_f32 v220, v37, v228, v220
    v_fma_f32 v221, v37, v229, v221
    v_fma_f32 v222, v37, v230, v222
    v_fma_f32 v223, v37, v231, v223
    v_fma_f32 v220, v38, v236, v220
    v_fma_f32 v221, v38, v237, v221
    v_fma_f32 v222, v38, v238, v222
    v_fma_f32 v223, v38, v239, v223
    v_fma_f32 v220, v39, v244, v220
    v_fma_f32 v221, v39, v245, v221
    v_fma_f32 v222, v39, v246, v222
    v_fma_f32 v223, v39, v247, v223
    v_mul_f32 v224, v36, v224
    v_mul_f32 v225, v36, v225
    v_mul_f32 v226, v36, v226
    v_mul_f32 v227, v36, v227
    v_fma_f32 v224, v37, v232, v224
    v_fma_f32 v225, v37, v233, v225
    v_fma_f32 v226, v37, v234, v226
    v_fma_f32 v227, v37, v235, v227
    v_fma_f32 v224, v38, v240, v224
    v_fma_f32 v225, v38, v241, v225
    v_fma_f32 v226, v38, v242, v226
    v_fma_f32 v227, v38, v243, v227
    v_fma_f32 v224, v39, v248, v224
    v_fma_f32 v225, v39, v249, v225
    v_fma_f32 v226, v39, v250, v226
    v_fma_f32 v227, v39, v251, v227
    v_cvt_pk_bf16_f32 v28, v220, v221
    v_cvt_pk_bf16_f32 v29, v222, v223
    v_cvt_pk_bf16_f32 v30, v224, v225
    v_cvt_pk_bf16_f32 v31, v226, v227
    v_perm_b32 v16, v96, v92, s27
    v_perm_b32 v17, v104, v100, s27
    v_perm_b32 v18, v112, v108, s27
    v_perm_b32 v19, v120, v116, s27
    v_perm_b32 v20, v96, v92, s28
    v_perm_b32 v21, v104, v100, s28
    v_perm_b32 v22, v112, v108, s28
    v_perm_b32 v23, v120, v116, s28
    v_mfma_f32_16x16x32_bf16 a[0:3], v[24:27], v[16:19], a[0:3]
    v_mfma_f32_16x16x32_bf16 a[32:35], v[28:31], v[16:19], a[32:35]
    v_perm_b32 v16, v97, v93, s27
    v_perm_b32 v17, v105, v101, s27
    v_perm_b32 v18, v113, v109, s27
    v_perm_b32 v19, v121, v117, s27
    v_mfma_f32_16x16x32_bf16 a[4:7], v[24:27], v[20:23], a[4:7]
    v_mfma_f32_16x16x32_bf16 a[36:39], v[28:31], v[20:23], a[36:39]
    v_perm_b32 v20, v97, v93, s28
    v_perm_b32 v21, v105, v101, s28
    v_perm_b32 v22, v113, v109, s28
    v_perm_b32 v23, v121, v117, s28
    v_mfma_f32_16x16x32_bf16 a[8:11], v[24:27], v[16:19], a[8:11]
    v_mfma_f32_16x16x32_bf16 a[40:43], v[28:31], v[16:19], a[40:43]
    v_perm_b32 v16, v98, v94, s27
    v_perm_b32 v17, v106, v102, s27
    v_perm_b32 v18, v114, v110, s27
    v_perm_b32 v19, v122, v118, s27
    v_mfma_f32_16x16x32_bf16 a[12:15], v[24:27], v[20:23], a[12:15]
    v_mfma_f32_16x16x32_bf16 a[44:47], v[28:31], v[20:23], a[44:47]
    v_perm_b32 v20, v98, v94, s28
    v_perm_b32 v21, v106, v102, s28
    v_perm_b32 v22, v114, v110, s28
    v_perm_b32 v23, v122, v118, s28
    v_mfma_f32_16x16x32_bf16 a[16:19], v[24:27], v[16:19], a[16:19]
    v_mfma_f32_16x16x32_bf16 a[48:51], v[28:31], v[16:19], a[48:51]
    v_perm_b32 v16, v99, v95, s27
    v_perm_b32 v17, v107, v103, s27
    v_perm_b32 v18, v115, v111, s27
    v_perm_b32 v19, v123, v119, s27
    v_mfma_f32_16x16x32_bf16 a[20:23], v[24:27], v[20:23], a[20:23]
    v_mfma_f32_16x16x32_bf16 a[52:55], v[28:31], v[20:23], a[52:55]
    v_perm_b32 v20, v99, v95, s28
    v_perm_b32 v21, v107, v103, s28
    v_perm_b32 v22, v115, v111, s28
    v_perm_b32 v23, v123, v119, s28
    v_mfma_f32_16x16x32_bf16 a[24:27], v[24:27], v[16:19], a[24:27]
    v_mfma_f32_16x16x32_bf16 a[56:59], v[28:31], v[16:19], a[56:59]
    s_nop 0
    v_mfma_f32_16x16x32_bf16 a[28:31], v[24:27], v[20:23], a[28:31]
    v_mfma_f32_16x16x32_bf16 a[60:63], v[28:31], v[20:23], a[60:63]
    buffer_load_dwordx4 v[92:95], v6, s[12:15], s29 offen offset:0 nt
    buffer_load_dwordx4 v[96:99], v7, s[12:15], s29 offen offset:0 nt
    buffer_load_dwordx4 v[100:103], v8, s[12:15], s29 offen offset:0 nt
    buffer_load_dwordx4 v[104:107], v9, s[12:15], s29 offen offset:0 nt
    buffer_load_dwordx4 v[108:111], v6, s[12:15], s29 offen offset:1024 nt
    buffer_load_dwordx4 v[112:115], v7, s[12:15], s29 offen offset:1024 nt
    buffer_load_dwordx4 v[116:119], v8, s[12:15], s29 offen offset:1024 nt
    buffer_load_dwordx4 v[120:123], v9, s[12:15], s29 offen offset:1024 nt
    s_add_u32 s29, s29, 32768
    s_add_u32 s33, s32, 0
    s_add_u32 s34, s32, 4096
    s_add_u32 s35, s32, 8192
    s_add_u32 s36, s32, 12288
    buffer_load_dwordx4 v[188:191], v10, s[16:19], s33 offen offset:0
    buffer_load_dwordx4 v[192:195], v10, s[16:19], s33 offen offset:1024
    buffer_load_dwordx4 v[196:199], v10, s[16:19], s33 offen offset:2048
    buffer_load_dwordx4 v[200:203], v10, s[16:19], s33 offen offset:3072
    buffer_load_dwordx4 v[204:207], v10, s[16:19], s34 offen offset:0
    buffer_load_dwordx4 v[208:211], v10, s[16:19], s34 offen offset:1024
    buffer_load_dwordx4 v[212:215], v10, s[16:19], s34 offen offset:2048
    buffer_load_dwordx4 v[216:219], v10, s[16:19], s34 offen offset:3072
    buffer_load_dwordx4 v[220:223], v10, s[16:19], s35 offen offset:0
    buffer_load_dwordx4 v[224:227], v10, s[16:19], s35 offen offset:1024
    buffer_load_dwordx4 v[228:231], v10, s[16:19], s35 offen offset:2048
    buffer_load_dwordx4 v[232:235], v10, s[16:19], s35 offen offset:3072
    buffer_load_dwordx4 v[236:239], v10, s[16:19], s36 offen offset:0
    buffer_load_dwordx4 v[240:243], v10, s[16:19], s36 offen offset:1024
    buffer_load_dwordx4 v[244:247], v10, s[16:19], s36 offen offset:2048
    buffer_load_dwordx4 v[248:251], v10, s[16:19], s36 offen offset:3072
    s_add_u32 s32, s32, 16384
    s_waitcnt vmcnt(24)
    v_mul_f32 v124, v32, v124
    v_mul_f32 v125, v32, v125
    v_mul_f32 v126, v32, v126
    v_mul_f32 v127, v32, v127
    v_fma_f32 v124, v33, v132, v124
    v_fma_f32 v125, v33, v133, v125
    v_fma_f32 v126, v33, v134, v126
    v_fma_f32 v127, v33, v135, v127
    v_fma_f32 v124, v34, v140, v124
    v_fma_f32 v125, v34, v141, v125
    v_fma_f32 v126, v34, v142, v126
    v_fma_f32 v127, v34, v143, v127
    v_fma_f32 v124, v35, v148, v124
    v_fma_f32 v125, v35, v149, v125
    v_fma_f32 v126, v35, v150, v126
    v_fma_f32 v127, v35, v151, v127
    v_mul_f32 v128, v32, v128
    v_mul_f32 v129, v32, v129
    v_mul_f32 v130, v32, v130
    v_mul_f32 v131, v32, v131
    v_fma_f32 v128, v33, v136, v128
    v_fma_f32 v129, v33, v137, v129
    v_fma_f32 v130, v33, v138, v130
    v_fma_f32 v131, v33, v139, v131
    v_fma_f32 v128, v34, v144, v128
    v_fma_f32 v129, v34, v145, v129
    v_fma_f32 v130, v34, v146, v130
    v_fma_f32 v131, v34, v147, v131
    v_fma_f32 v128, v35, v152, v128
    v_fma_f32 v129, v35, v153, v129
    v_fma_f32 v130, v35, v154, v130
    v_fma_f32 v131, v35, v155, v131
    v_cvt_pk_bf16_f32 v24, v124, v125
    v_cvt_pk_bf16_f32 v25, v126, v127
    v_cvt_pk_bf16_f32 v26, v128, v129
    v_cvt_pk_bf16_f32 v27, v130, v131
    v_mul_f32 v156, v36, v156
    v_mul_f32 v157, v36, v157
    v_mul_f32 v158, v36, v158
    v_mul_f32 v159, v36, v159
    v_fma_f32 v156, v37, v164, v156
    v_fma_f32 v157, v37, v165, v157
    v_fma_f32 v158, v37, v166, v158
    v_fma_f32 v159, v37, v167, v159
    v_fma_f32 v156, v38, v172, v156
    v_fma_f32 v157, v38, v173, v157
    v_fma_f32 v158, v38, v174, v158
    v_fma_f32 v159, v38, v175, v159
    v_fma_f32 v156, v39, v180, v156
    v_fma_f32 v157, v39, v181, v157
    v_fma_f32 v158, v39, v182, v158
    v_fma_f32 v159, v39, v183, v159
    v_mul_f32 v160, v36, v160
    v_mul_f32 v161, v36, v161
    v_mul_f32 v162, v36, v162
    v_mul_f32 v163, v36, v163
    v_fma_f32 v160, v37, v168, v160
    v_fma_f32 v161, v37, v169, v161
    v_fma_f32 v162, v37, v170, v162
    v_fma_f32 v163, v37, v171, v163
    v_fma_f32 v160, v38, v176, v160
    v_fma_f32 v161, v38, v177, v161
    v_fma_f32 v162, v38, v178, v162
    v_fma_f32 v163, v38, v179, v163
    v_fma_f32 v160, v39, v184, v160
    v_fma_f32 v161, v39, v185, v161
    v_fma_f32 v162, v39, v186, v162
    v_fma_f32 v163, v39, v187, v163
    v_cvt_pk_bf16_f32 v28, v156, v157
    v_cvt_pk_bf16_f32 v29, v158, v159
    v_cvt_pk_bf16_f32 v30, v160, v161
    v_cvt_pk_bf16_f32 v31, v162, v163
    v_perm_b32 v16, v64, v60, s27
    v_perm_b32 v17, v72, v68, s27
    v_perm_b32 v18, v80, v76, s27
    v_perm_b32 v19, v88, v84, s27
    v_perm_b32 v20, v64, v60, s28
    v_perm_b32 v21, v72, v68, s28
    v_perm_b32 v22, v80, v76, s28
    v_perm_b32 v23, v88, v84, s28
    v_mfma_f32_16x16x32_bf16 a[0:3], v[24:27], v[16:19], a[0:3]
    v_mfma_f32_16x16x32_bf16 a[32:35], v[28:31], v[16:19], a[32:35]
    v_perm_b32 v16, v65, v61, s27
    v_perm_b32 v17, v73, v69, s27
    v_perm_b32 v18, v81, v77, s27
    v_perm_b32 v19, v89, v85, s27
    v_mfma_f32_16x16x32_bf16 a[4:7], v[24:27], v[20:23], a[4:7]
    v_mfma_f32_16x16x32_bf16 a[36:39], v[28:31], v[20:23], a[36:39]
    v_perm_b32 v20, v65, v61, s28
    v_perm_b32 v21, v73, v69, s28
    v_perm_b32 v22, v81, v77, s28
    v_perm_b32 v23, v89, v85, s28
    v_mfma_f32_16x16x32_bf16 a[8:11], v[24:27], v[16:19], a[8:11]
    v_mfma_f32_16x16x32_bf16 a[40:43], v[28:31], v[16:19], a[40:43]
    v_perm_b32 v16, v66, v62, s27
    v_perm_b32 v17, v74, v70, s27
    v_perm_b32 v18, v82, v78, s27
    v_perm_b32 v19, v90, v86, s27
    v_mfma_f32_16x16x32_bf16 a[12:15], v[24:27], v[20:23], a[12:15]
    v_mfma_f32_16x16x32_bf16 a[44:47], v[28:31], v[20:23], a[44:47]
    v_perm_b32 v20, v66, v62, s28
    v_perm_b32 v21, v74, v70, s28
    v_perm_b32 v22, v82, v78, s28
    v_perm_b32 v23, v90, v86, s28
    v_mfma_f32_16x16x32_bf16 a[16:19], v[24:27], v[16:19], a[16:19]
    v_mfma_f32_16x16x32_bf16 a[48:51], v[28:31], v[16:19], a[48:51]
    v_perm_b32 v16, v67, v63, s27
    v_perm_b32 v17, v75, v71, s27
    v_perm_b32 v18, v83, v79, s27
    v_perm_b32 v19, v91, v87, s27
    v_mfma_f32_16x16x32_bf16 a[20:23], v[24:27], v[20:23], a[20:23]
    v_mfma_f32_16x16x32_bf16 a[52:55], v[28:31], v[20:23], a[52:55]
    v_perm_b32 v20, v67, v63, s28
    v_perm_b32 v21, v75, v71, s28
    v_perm_b32 v22, v83, v79, s28
    v_perm_b32 v23, v91, v87, s28
    v_mfma_f32_16x16x32_bf16 a[24:27], v[24:27], v[16:19], a[24:27]
    v_mfma_f32_16x16x32_bf16 a[56:59], v[28:31], v[16:19], a[56:59]
    s_nop 0
    v_mfma_f32_16x16x32_bf16 a[28:31], v[24:27], v[20:23], a[28:31]
    v_mfma_f32_16x16x32_bf16 a[60:63], v[28:31], v[20:23], a[60:63]
    s_waitcnt vmcnt(0)
    v_mul_f32 v188, v32, v188
    v_mul_f32 v189, v32, v189
    v_mul_f32 v190, v32, v190
    v_mul_f32 v191, v32, v191
    v_fma_f32 v188, v33, v196, v188
    v_fma_f32 v189, v33, v197, v189
    v_fma_f32 v190, v33, v198, v190
    v_fma_f32 v191, v33, v199, v191
    v_fma_f32 v188, v34, v204, v188
    v_fma_f32 v189, v34, v205, v189
    v_fma_f32 v190, v34, v206, v190
    v_fma_f32 v191, v34, v207, v191
    v_fma_f32 v188, v35, v212, v188
    v_fma_f32 v189, v35, v213, v189
    v_fma_f32 v190, v35, v214, v190
    v_fma_f32 v191, v35, v215, v191
    v_mul_f32 v192, v32, v192
    v_mul_f32 v193, v32, v193
    v_mul_f32 v194, v32, v194
    v_mul_f32 v195, v32, v195
    v_fma_f32 v192, v33, v200, v192
    v_fma_f32 v193, v33, v201, v193
    v_fma_f32 v194, v33, v202, v194
    v_fma_f32 v195, v33, v203, v195
    v_fma_f32 v192, v34, v208, v192
    v_fma_f32 v193, v34, v209, v193
    v_fma_f32 v194, v34, v210, v194
    v_fma_f32 v195, v34, v211, v195
    v_fma_f32 v192, v35, v216, v192
    v_fma_f32 v193, v35, v217, v193
    v_fma_f32 v194, v35, v218, v194
    v_fma_f32 v195, v35, v219, v195
    v_cvt_pk_bf16_f32 v24, v188, v189
    v_cvt_pk_bf16_f32 v25, v190, v191
    v_cvt_pk_bf16_f32 v26, v192, v193
    v_cvt_pk_bf16_f32 v27, v194, v195
    v_mul_f32 v220, v36, v220
    v_mul_f32 v221, v36, v221
    v_mul_f32 v222, v36, v222
    v_mul_f32 v223, v36, v223
    v_fma_f32 v220, v37, v228, v220
    v_fma_f32 v221, v37, v229, v221
    v_fma_f32 v222, v37, v230, v222
    v_fma_f32 v223, v37, v231, v223
    v_fma_f32 v220, v38, v236, v220
    v_fma_f32 v221, v38, v237, v221
    v_fma_f32 v222, v38, v238, v222
    v_fma_f32 v223, v38, v239, v223
    v_fma_f32 v220, v39, v244, v220
    v_fma_f32 v221, v39, v245, v221
    v_fma_f32 v222, v39, v246, v222
    v_fma_f32 v223, v39, v247, v223
    v_mul_f32 v224, v36, v224
    v_mul_f32 v225, v36, v225
    v_mul_f32 v226, v36, v226
    v_mul_f32 v227, v36, v227
    v_fma_f32 v224, v37, v232, v224
    v_fma_f32 v225, v37, v233, v225
    v_fma_f32 v226, v37, v234, v226
    v_fma_f32 v227, v37, v235, v227
    v_fma_f32 v224, v38, v240, v224
    v_fma_f32 v225, v38, v241, v225
    v_fma_f32 v226, v38, v242, v226
    v_fma_f32 v227, v38, v243, v227
    v_fma_f32 v224, v39, v248, v224
    v_fma_f32 v225, v39, v249, v225
    v_fma_f32 v226, v39, v250, v226
    v_fma_f32 v227, v39, v251, v227
    v_cvt_pk_bf16_f32 v28, v220, v221
    v_cvt_pk_bf16_f32 v29, v222, v223
    v_cvt_pk_bf16_f32 v30, v224, v225
    v_cvt_pk_bf16_f32 v31, v226, v227
    v_perm_b32 v16, v96, v92, s27
    v_perm_b32 v17, v104, v100, s27
    v_perm_b32 v18, v112, v108, s27
    v_perm_b32 v19, v120, v116, s27
    v_perm_b32 v20, v96, v92, s28
    v_perm_b32 v21, v104, v100, s28
    v_perm_b32 v22, v112, v108, s28
    v_perm_b32 v23, v120, v116, s28
    v_mfma_f32_16x16x32_bf16 a[0:3], v[24:27], v[16:19], a[0:3]
    v_mfma_f32_16x16x32_bf16 a[32:35], v[28:31], v[16:19], a[32:35]
    v_perm_b32 v16, v97, v93, s27
    v_perm_b32 v17, v105, v101, s27
    v_perm_b32 v18, v113, v109, s27
    v_perm_b32 v19, v121, v117, s27
    v_mfma_f32_16x16x32_bf16 a[4:7], v[24:27], v[20:23], a[4:7]
    v_mfma_f32_16x16x32_bf16 a[36:39], v[28:31], v[20:23], a[36:39]
    v_perm_b32 v20, v97, v93, s28
    v_perm_b32 v21, v105, v101, s28
    v_perm_b32 v22, v113, v109, s28
    v_perm_b32 v23, v121, v117, s28
    v_mfma_f32_16x16x32_bf16 a[8:11], v[24:27], v[16:19], a[8:11]
    v_mfma_f32_16x16x32_bf16 a[40:43], v[28:31], v[16:19], a[40:43]
    v_perm_b32 v16, v98, v94, s27
    v_perm_b32 v17, v106, v102, s27
    v_perm_b32 v18, v114, v110, s27
    v_perm_b32 v19, v122, v118, s27
    v_mfma_f32_16x16x32_bf16 a[12:15], v[24:27], v[20:23], a[12:15]
    v_mfma_f32_16x16x32_bf16 a[44:47], v[28:31], v[20:23], a[44:47]
    v_perm_b32 v20, v98, v94, s28
    v_perm_b32 v21, v106, v102, s28
    v_perm_b32 v22, v114, v110, s28
    v_perm_b32 v23, v122, v118, s28
    v_mfma_f32_16x16x32_bf16 a[16:19], v[24:27], v[16:19], a[16:19]
    v_mfma_f32_16x16x32_bf16 a[48:51], v[28:31], v[16:19], a[48:51]
    v_perm_b32 v16, v99, v95, s27
    v_perm_b32 v17, v107, v103, s27
    v_perm_b32 v18, v115, v111, s27
    v_perm_b32 v19, v123, v119, s27
    v_mfma_f32_16x16x32_bf16 a[20:23], v[24:27], v[20:23], a[20:23]
    v_mfma_f32_16x16x32_bf16 a[52:55], v[28:31], v[20:23], a[52:55]
    v_perm_b32 v20, v99, v95, s28
    v_perm_b32 v21, v107, v103, s28
    v_perm_b32 v22, v115, v111, s28
    v_perm_b32 v23, v123, v119, s28
    v_mfma_f32_16x16x32_bf16 a[24:27], v[24:27], v[16:19], a[24:27]
    v_mfma_f32_16x16x32_bf16 a[56:59], v[28:31], v[16:19], a[56:59]
    s_nop 0
    v_mfma_f32_16x16x32_bf16 a[28:31], v[24:27], v[20:23], a[28:31]
    v_mfma_f32_16x16x32_bf16 a[60:63], v[28:31], v[20:23], a[60:63]
    s_nop 7
    v_lshlrev_b32 v3, 13, v2
    v_lshlrev_b32 v4, 5, v1
    v_add_u32 v3, v3, v4
    v_add_u32 v4, 4096, v3
    s_lshl_b32 s25, s40, 16
    s_and_b32 s26, s2, 3
    s_lshl_b32 s26, s26, 9
    s_add_u32 s25, s25, s26
    s_add_u32 s25, s25, 2392064
    s_add_u32 s26, s25, 32768
    v_accvgpr_read_b32 v124, a0
    v_accvgpr_read_b32 v125, a4
    v_accvgpr_read_b32 v126, a8
    v_accvgpr_read_b32 v127, a12
    v_accvgpr_read_b32 v128, a16
    v_accvgpr_read_b32 v129, a20
    v_accvgpr_read_b32 v130, a24
    v_accvgpr_read_b32 v131, a28
    v_accvgpr_read_b32 v132, a1
    v_accvgpr_read_b32 v133, a5
    v_accvgpr_read_b32 v134, a9
    v_accvgpr_read_b32 v135, a13
    v_accvgpr_read_b32 v136, a17
    v_accvgpr_read_b32 v137, a21
    v_accvgpr_read_b32 v138, a25
    v_accvgpr_read_b32 v139, a29
    v_accvgpr_read_b32 v140, a2
    v_accvgpr_read_b32 v141, a6
    v_accvgpr_read_b32 v142, a10
    v_accvgpr_read_b32 v143, a14
    v_accvgpr_read_b32 v144, a18
    v_accvgpr_read_b32 v145, a22
    v_accvgpr_read_b32 v146, a26
    v_accvgpr_read_b32 v147, a30
    v_accvgpr_read_b32 v148, a3
    v_accvgpr_read_b32 v149, a7
    v_accvgpr_read_b32 v150, a11
    v_accvgpr_read_b32 v151, a15
    v_accvgpr_read_b32 v152, a19
    v_accvgpr_read_b32 v153, a23
    v_accvgpr_read_b32 v154, a27
    v_accvgpr_read_b32 v155, a31
    v_accvgpr_read_b32 v156, a32
    v_accvgpr_read_b32 v157, a36
    v_accvgpr_read_b32 v158, a40
    v_accvgpr_read_b32 v159, a44
    v_accvgpr_read_b32 v160, a48
    v_accvgpr_read_b32 v161, a52
    v_accvgpr_read_b32 v162, a56
    v_accvgpr_read_b32 v163, a60
    v_accvgpr_read_b32 v164, a33
    v_accvgpr_read_b32 v165, a37
    v_accvgpr_read_b32 v166, a41
    v_accvgpr_read_b32 v167, a45
    v_accvgpr_read_b32 v168, a49
    v_accvgpr_read_b32 v169, a53
    v_accvgpr_read_b32 v170, a57
    v_accvgpr_read_b32 v171, a61
    v_accvgpr_read_b32 v172, a34
    v_accvgpr_read_b32 v173, a38
    v_accvgpr_read_b32 v174, a42
    v_accvgpr_read_b32 v175, a46
    v_accvgpr_read_b32 v176, a50
    v_accvgpr_read_b32 v177, a54
    v_accvgpr_read_b32 v178, a58
    v_accvgpr_read_b32 v179, a62
    v_accvgpr_read_b32 v180, a35
    v_accvgpr_read_b32 v181, a39
    v_accvgpr_read_b32 v182, a43
    v_accvgpr_read_b32 v183, a47
    v_accvgpr_read_b32 v184, a51
    v_accvgpr_read_b32 v185, a55
    v_accvgpr_read_b32 v186, a59
    v_accvgpr_read_b32 v187, a63
    buffer_store_dwordx4 v[124:127], v3, s[16:19], s25 offen offset:0
    buffer_store_dwordx4 v[128:131], v3, s[16:19], s25 offen offset:16
    buffer_store_dwordx4 v[132:135], v3, s[16:19], s25 offen offset:2048
    buffer_store_dwordx4 v[136:139], v3, s[16:19], s25 offen offset:2064
    buffer_store_dwordx4 v[140:143], v4, s[16:19], s25 offen offset:0
    buffer_store_dwordx4 v[144:147], v4, s[16:19], s25 offen offset:16
    buffer_store_dwordx4 v[148:151], v4, s[16:19], s25 offen offset:2048
    buffer_store_dwordx4 v[152:155], v4, s[16:19], s25 offen offset:2064
    buffer_store_dwordx4 v[156:159], v3, s[16:19], s26 offen offset:0
    buffer_store_dwordx4 v[160:163], v3, s[16:19], s26 offen offset:16
    buffer_store_dwordx4 v[164:167], v3, s[16:19], s26 offen offset:2048
    buffer_store_dwordx4 v[168:171], v3, s[16:19], s26 offen offset:2064
    buffer_store_dwordx4 v[172:175], v4, s[16:19], s26 offen offset:0
    buffer_store_dwordx4 v[176:179], v4, s[16:19], s26 offen offset:16
    buffer_store_dwordx4 v[180:183], v4, s[16:19], s26 offen offset:2048
    buffer_store_dwordx4 v[184:187], v4, s[16:19], s26 offen offset:2064
oproj_kernel_end:
    s_endpgm

.globl oreduce_kernel
.p2align 8
.type oreduce_kernel,@function
oreduce_kernel:
    s_cmp_ge_u32 s2, 64
    s_cbranch_scc1 oreduce_kernel_end
    s_load_dwordx4 s[4:7], s[0:1], 40
    s_load_dwordx2 s[8:9], s[0:1], 56
    s_lshl_b32 s3, s2, 6
    v_add_u32 v1, s3, v0
    v_lshlrev_b32 v2, 3, v1
    v_lshlrev_b32 v1, 4, v1
    s_waitcnt lgkmcnt(0)
    s_mov_b32 s12, s8
    s_mov_b32 s13, s9
    s_mov_b32 s14, 16777216
    s_mov_b32 s15, 0x00020000
    s_mov_b32 s16, s4
    s_mov_b32 s17, s5
    s_mov_b32 s18, 32768
    s_mov_b32 s19, 0x00020000
    s_mov_b32 s20, 2392064
    buffer_load_dwordx4 v[4:7], v1, s[12:15], s20 offen
    s_add_u32 s20, s20, 65536
    buffer_load_dwordx4 v[8:11], v1, s[12:15], s20 offen
    s_add_u32 s20, s20, 65536
    buffer_load_dwordx4 v[12:15], v1, s[12:15], s20 offen
    s_add_u32 s20, s20, 65536
    buffer_load_dwordx4 v[16:19], v1, s[12:15], s20 offen
    s_add_u32 s20, s20, 65536
    buffer_load_dwordx4 v[20:23], v1, s[12:15], s20 offen
    s_add_u32 s20, s20, 65536
    buffer_load_dwordx4 v[24:27], v1, s[12:15], s20 offen
    s_add_u32 s20, s20, 65536
    buffer_load_dwordx4 v[28:31], v1, s[12:15], s20 offen
    s_add_u32 s20, s20, 65536
    buffer_load_dwordx4 v[32:35], v1, s[12:15], s20 offen
    s_add_u32 s20, s20, 65536
    buffer_load_dwordx4 v[36:39], v1, s[12:15], s20 offen
    s_add_u32 s20, s20, 65536
    buffer_load_dwordx4 v[40:43], v1, s[12:15], s20 offen
    s_add_u32 s20, s20, 65536
    buffer_load_dwordx4 v[44:47], v1, s[12:15], s20 offen
    s_add_u32 s20, s20, 65536
    buffer_load_dwordx4 v[48:51], v1, s[12:15], s20 offen
    s_add_u32 s20, s20, 65536
    buffer_load_dwordx4 v[52:55], v1, s[12:15], s20 offen
    s_add_u32 s20, s20, 65536
    buffer_load_dwordx4 v[56:59], v1, s[12:15], s20 offen
    s_add_u32 s20, s20, 65536
    buffer_load_dwordx4 v[60:63], v1, s[12:15], s20 offen
    s_add_u32 s20, s20, 65536
    buffer_load_dwordx4 v[64:67], v1, s[12:15], s20 offen
    s_add_u32 s20, s20, 65536
    buffer_load_dwordx4 v[68:71], v1, s[12:15], s20 offen
    s_add_u32 s20, s20, 65536
    buffer_load_dwordx4 v[72:75], v1, s[12:15], s20 offen
    s_add_u32 s20, s20, 65536
    buffer_load_dwordx4 v[76:79], v1, s[12:15], s20 offen
    s_add_u32 s20, s20, 65536
    buffer_load_dwordx4 v[80:83], v1, s[12:15], s20 offen
    s_add_u32 s20, s20, 65536
    buffer_load_dwordx4 v[84:87], v1, s[12:15], s20 offen
    s_add_u32 s20, s20, 65536
    buffer_load_dwordx4 v[88:91], v1, s[12:15], s20 offen
    s_add_u32 s20, s20, 65536
    buffer_load_dwordx4 v[92:95], v1, s[12:15], s20 offen
    s_add_u32 s20, s20, 65536
    buffer_load_dwordx4 v[96:99], v1, s[12:15], s20 offen
    s_add_u32 s20, s20, 65536
    buffer_load_dwordx4 v[100:103], v1, s[12:15], s20 offen
    s_add_u32 s20, s20, 65536
    buffer_load_dwordx4 v[104:107], v1, s[12:15], s20 offen
    s_add_u32 s20, s20, 65536
    buffer_load_dwordx4 v[108:111], v1, s[12:15], s20 offen
    s_add_u32 s20, s20, 65536
    buffer_load_dwordx4 v[112:115], v1, s[12:15], s20 offen
    s_add_u32 s20, s20, 65536
    buffer_load_dwordx4 v[116:119], v1, s[12:15], s20 offen
    s_add_u32 s20, s20, 65536
    buffer_load_dwordx4 v[120:123], v1, s[12:15], s20 offen
    s_add_u32 s20, s20, 65536
    buffer_load_dwordx4 v[124:127], v1, s[12:15], s20 offen
    s_add_u32 s20, s20, 65536
    buffer_load_dwordx4 v[128:131], v1, s[12:15], s20 offen
    s_waitcnt vmcnt(30)
    v_add_f32 v4, v4, v8
    v_add_f32 v5, v5, v9
    v_add_f32 v6, v6, v10
    v_add_f32 v7, v7, v11
    s_waitcnt vmcnt(29)
    v_add_f32 v4, v4, v12
    v_add_f32 v5, v5, v13
    v_add_f32 v6, v6, v14
    v_add_f32 v7, v7, v15
    s_waitcnt vmcnt(28)
    v_add_f32 v4, v4, v16
    v_add_f32 v5, v5, v17
    v_add_f32 v6, v6, v18
    v_add_f32 v7, v7, v19
    s_waitcnt vmcnt(27)
    v_add_f32 v4, v4, v20
    v_add_f32 v5, v5, v21
    v_add_f32 v6, v6, v22
    v_add_f32 v7, v7, v23
    s_waitcnt vmcnt(26)
    v_add_f32 v4, v4, v24
    v_add_f32 v5, v5, v25
    v_add_f32 v6, v6, v26
    v_add_f32 v7, v7, v27
    s_waitcnt vmcnt(25)
    v_add_f32 v4, v4, v28
    v_add_f32 v5, v5, v29
    v_add_f32 v6, v6, v30
    v_add_f32 v7, v7, v31
    s_waitcnt vmcnt(24)
    v_add_f32 v4, v4, v32
    v_add_f32 v5, v5, v33
    v_add_f32 v6, v6, v34
    v_add_f32 v7, v7, v35
    s_waitcnt vmcnt(23)
    v_add_f32 v4, v4, v36
    v_add_f32 v5, v5, v37
    v_add_f32 v6, v6, v38
    v_add_f32 v7, v7, v39
    s_waitcnt vmcnt(22)
    v_add_f32 v4, v4, v40
    v_add_f32 v5, v5, v41
    v_add_f32 v6, v6, v42
    v_add_f32 v7, v7, v43
    s_waitcnt vmcnt(21)
    v_add_f32 v4, v4, v44
    v_add_f32 v5, v5, v45
    v_add_f32 v6, v6, v46
    v_add_f32 v7, v7, v47
    s_waitcnt vmcnt(20)
    v_add_f32 v4, v4, v48
    v_add_f32 v5, v5, v49
    v_add_f32 v6, v6, v50
    v_add_f32 v7, v7, v51
    s_waitcnt vmcnt(19)
    v_add_f32 v4, v4, v52
    v_add_f32 v5, v5, v53
    v_add_f32 v6, v6, v54
    v_add_f32 v7, v7, v55
    s_waitcnt vmcnt(18)
    v_add_f32 v4, v4, v56
    v_add_f32 v5, v5, v57
    v_add_f32 v6, v6, v58
    v_add_f32 v7, v7, v59
    s_waitcnt vmcnt(17)
    v_add_f32 v4, v4, v60
    v_add_f32 v5, v5, v61
    v_add_f32 v6, v6, v62
    v_add_f32 v7, v7, v63
    s_waitcnt vmcnt(16)
    v_add_f32 v4, v4, v64
    v_add_f32 v5, v5, v65
    v_add_f32 v6, v6, v66
    v_add_f32 v7, v7, v67
    s_waitcnt vmcnt(15)
    v_add_f32 v4, v4, v68
    v_add_f32 v5, v5, v69
    v_add_f32 v6, v6, v70
    v_add_f32 v7, v7, v71
    s_waitcnt vmcnt(14)
    v_add_f32 v4, v4, v72
    v_add_f32 v5, v5, v73
    v_add_f32 v6, v6, v74
    v_add_f32 v7, v7, v75
    s_waitcnt vmcnt(13)
    v_add_f32 v4, v4, v76
    v_add_f32 v5, v5, v77
    v_add_f32 v6, v6, v78
    v_add_f32 v7, v7, v79
    s_waitcnt vmcnt(12)
    v_add_f32 v4, v4, v80
    v_add_f32 v5, v5, v81
    v_add_f32 v6, v6, v82
    v_add_f32 v7, v7, v83
    s_waitcnt vmcnt(11)
    v_add_f32 v4, v4, v84
    v_add_f32 v5, v5, v85
    v_add_f32 v6, v6, v86
    v_add_f32 v7, v7, v87
    s_waitcnt vmcnt(10)
    v_add_f32 v4, v4, v88
    v_add_f32 v5, v5, v89
    v_add_f32 v6, v6, v90
    v_add_f32 v7, v7, v91
    s_waitcnt vmcnt(9)
    v_add_f32 v4, v4, v92
    v_add_f32 v5, v5, v93
    v_add_f32 v6, v6, v94
    v_add_f32 v7, v7, v95
    s_waitcnt vmcnt(8)
    v_add_f32 v4, v4, v96
    v_add_f32 v5, v5, v97
    v_add_f32 v6, v6, v98
    v_add_f32 v7, v7, v99
    s_waitcnt vmcnt(7)
    v_add_f32 v4, v4, v100
    v_add_f32 v5, v5, v101
    v_add_f32 v6, v6, v102
    v_add_f32 v7, v7, v103
    s_waitcnt vmcnt(6)
    v_add_f32 v4, v4, v104
    v_add_f32 v5, v5, v105
    v_add_f32 v6, v6, v106
    v_add_f32 v7, v7, v107
    s_waitcnt vmcnt(5)
    v_add_f32 v4, v4, v108
    v_add_f32 v5, v5, v109
    v_add_f32 v6, v6, v110
    v_add_f32 v7, v7, v111
    s_waitcnt vmcnt(4)
    v_add_f32 v4, v4, v112
    v_add_f32 v5, v5, v113
    v_add_f32 v6, v6, v114
    v_add_f32 v7, v7, v115
    s_waitcnt vmcnt(3)
    v_add_f32 v4, v4, v116
    v_add_f32 v5, v5, v117
    v_add_f32 v6, v6, v118
    v_add_f32 v7, v7, v119
    s_waitcnt vmcnt(2)
    v_add_f32 v4, v4, v120
    v_add_f32 v5, v5, v121
    v_add_f32 v6, v6, v122
    v_add_f32 v7, v7, v123
    s_waitcnt vmcnt(1)
    v_add_f32 v4, v4, v124
    v_add_f32 v5, v5, v125
    v_add_f32 v6, v6, v126
    v_add_f32 v7, v7, v127
    s_waitcnt vmcnt(0)
    v_add_f32 v4, v4, v128
    v_add_f32 v5, v5, v129
    v_add_f32 v6, v6, v130
    v_add_f32 v7, v7, v131
    v_cvt_pk_bf16_f32 v132, v4, v5
    v_cvt_pk_bf16_f32 v133, v6, v7
    buffer_store_dwordx2 v[132:133], v2, s[16:19], 0 offen
oreduce_kernel_end:
    s_endpgm

.section .rodata,"a"
.p2align 6
.amdhsa_kernel qproj_kernel
  .amdhsa_next_free_vgpr 126
  .amdhsa_next_free_sgpr 40
  .amdhsa_accum_offset 128
  .amdhsa_group_segment_fixed_size 0
  .amdhsa_kernarg_size 64
  .amdhsa_user_sgpr_count 2
  .amdhsa_user_sgpr_kernarg_segment_ptr 1
  .amdhsa_system_sgpr_workgroup_id_x 1
.end_amdhsa_kernel
.p2align 6
.amdhsa_kernel attn_kernel
  .amdhsa_next_free_vgpr 216
  .amdhsa_next_free_sgpr 40
  .amdhsa_accum_offset 216
  .amdhsa_group_segment_fixed_size 0
  .amdhsa_kernarg_size 64
  .amdhsa_user_sgpr_count 2
  .amdhsa_user_sgpr_kernarg_segment_ptr 1
  .amdhsa_system_sgpr_workgroup_id_x 1
.end_amdhsa_kernel
.p2align 6
.amdhsa_kernel oproj_kernel
  .amdhsa_next_free_vgpr 316
  .amdhsa_next_free_sgpr 48
  .amdhsa_accum_offset 252
  .amdhsa_group_segment_fixed_size 0
  .amdhsa_kernarg_size 64
  .amdhsa_user_sgpr_count 2
  .amdhsa_user_sgpr_kernarg_segment_ptr 1
  .amdhsa_system_sgpr_workgroup_id_x 1
.end_amdhsa_kernel
.p2align 6
.amdhsa_kernel oreduce_kernel
  .amdhsa_next_free_vgpr 134
  .amdhsa_next_free_sgpr 32
  .amdhsa_accum_offset 136
  .amdhsa_group_segment_fixed_size 0
  .amdhsa_kernarg_size 64
  .amdhsa_user_sgpr_count 2
  .amdhsa_user_sgpr_kernarg_segment_ptr 1
  .amdhsa_system_sgpr_workgroup_id_x 1
.end_amdhsa_kernel
```
